```python
import torch

def _softmax(x, axis=-1):
    return torch.softmax(x, dim=axis)
def _gelu(x):
    return torch.nn.functional.gelu(x, approximate="tanh")
def _silu(x):
    return torch.nn.functional.silu(x)
def _sigmoid(x):
    return torch.sigmoid(x)
def _layernorm(x, axis=-1, eps=1e-5):
    m = x.mean(dim=axis, keepdim=True)
    v = x.var(dim=axis, keepdim=True, unbiased=False)
    return (x - m) / torch.sqrt(v + eps)
def _scatter_add(tgt, idx, src, axis=0):
    return tgt.clone().index_add_(axis, idx, src)
def _segment_sum(src, seg, n):
    out = torch.zeros((n,) + src.shape[1:], dtype=src.dtype)
    return out.index_add_(0, seg, src)
def _pad(x, pw):
    flat = tuple(v for pair in reversed(pw) for v in pair)
    return torch.nn.functional.pad(x, flat)

kernel_name = 'gated_mix__linear_kernel_hedgehog__dense_activation_gelu__prompt'

def setup_inputs():

    _w = (lambda a: (lambda t: t.to(torch.bfloat16) if t.is_floating_point() else t)(torch.as_tensor(a)))
    def _A_setup():
        B, S, D, H = 1, 2048, 512, 32
        Dh = D // H
        return {
            "x": _w((lambda *s: torch.randn(*s, dtype=torch.bfloat16) * 0.05)(B, S, D)),
            "wqkv": _w((lambda *s: torch.randn(*s, dtype=torch.bfloat16) * 0.8)(D, 3 * D)),
            "w_phi": _w((lambda *s: torch.randn(*s, dtype=torch.bfloat16) * 0.8)(H, Dh, Dh) * (Dh ** -0.5)),
            "wo": _w((lambda *s: torch.randn(*s, dtype=torch.bfloat16) * 0.05)(D, D)),
        }
    _A_in = _A_setup()

    def _B_setup():
        B, S, D, F = 1, 2048, 512, 1376
        return {
            "x": _w((lambda *s: torch.randn(*s, dtype=torch.bfloat16) * 0.05)(B, S, D)),
            "w1": _w((lambda *s: torch.randn(*s, dtype=torch.bfloat16) * 3.2)(D, F) * (D ** -0.5)),
            "b1": _w((lambda *s: torch.randn(*s, dtype=torch.bfloat16) * 3.2)(F) * 0.01),
            "w2": _w((lambda *s: torch.randn(*s, dtype=torch.bfloat16) * 0.2)(F, D) * (F ** -0.5)),
            "b2": _w((lambda *s: torch.randn(*s, dtype=torch.bfloat16) * 0.4)(D) * 0.01),
        }
    _B_in = _B_setup()

    return {
        "A_x": _A_in["x"],
        "A_wqkv": _A_in["wqkv"],
        "A_w_phi": _A_in["w_phi"],
        "A_wo": _A_in["wo"],
        "B_x": _B_in["x"],
        "B_w1": _B_in["w1"],
        "B_b1": _B_in["b1"],
        "B_w2": _B_in["w2"],
        "B_b2": _B_in["b2"],
        "gate_w": _w((lambda *s: torch.randn(*s, dtype=torch.bfloat16) * 0.05)(512) * 16.0),
    }

def reference(A_x, A_wqkv, A_w_phi, A_wo, B_x, B_w1, B_b1, B_w2, B_b2, gate_w):
    def _A_ref(x, wqkv, w_phi, wo):
        B, S, D = x.shape
        H = 32; Dh = D // H
        qkv = (lambda x, *d: x.permute(*d))((x @ wqkv).reshape(B, S, 3, H, Dh), 2, 0, 3, 1, 4)
        q, k, v = qkv[0], qkv[1], qkv[2]
        pq = torch.einsum("bhsd,hdf->bhsf", q, w_phi)
        pk = torch.einsum("bhsd,hdf->bhsf", k, w_phi)
        phi_q = torch.concatenate([_softmax(pq, axis=-1), _softmax(-pq, axis=-1)], axis=-1)
        phi_k = torch.concatenate([_softmax(pk, axis=-1), _softmax(-pk, axis=-1)], axis=-1)
        kv = torch.einsum("bhsf,bhsd->bhfd", phi_k, v)
        z  = torch.einsum("bhsf->bhf", phi_k)
        num = torch.einsum("bhqf,bhfd->bhqd", phi_q, kv)
        den = torch.einsum("bhqf,bhf->bhq", phi_q, z)[..., None] + 1e-6
        o = num / den
        return (lambda x, *d: x.permute(*d))(o, 0, 2, 1, 3).reshape(B, S, D) @ wo

    def _B_ref(x, w1, b1, w2, b2):
        h = torch.einsum("bsd,df->bsf", x, w1) + b1
        h = _gelu(h)
        return torch.einsum("bsf,fd->bsd", h, w2) + b2

    x = A_x
    g = _sigmoid((x * gate_w).sum(-1, keepdims=True))
    a = _A_ref(x, A_wqkv, A_w_phi, A_wo)
    b = _B_ref(x, B_w1, B_b1, B_w2, B_b2)
    return g * a + (1 - g) * b
```

```asm
; @launch grid=(256,1,1) block=(512,1,1) lds=163840
.amdgcn_target "amdgcn-amd-amdhsa--gfx950"
.text
.globl gated_mix__linear_kernel_hedgehog__dense_activation_gelu__prompt_kernel
.p2align 8
.type gated_mix__linear_kernel_hedgehog__dense_activation_gelu__prompt_kernel,@function
gated_mix__linear_kernel_hedgehog__dense_activation_gelu__prompt_kernel:
  s_cmp_ge_u32 s2, 256
  s_cbranch_scc1 L_end
  s_load_dwordx16 s[4:19], s[0:1], 0
  s_load_dwordx8 s[20:27], s[0:1], 64
  s_load_dwordx2 s[28:29], s[0:1], 96
  v_lshrrev_b32 v28, 6, v0
  s_lshr_b32 s73, s2, 3
  s_getpc_b64 s[74:75]
  s_mul_i32 s72, s73, 1280
  v_mul_u32_u24 v29, 5, v0
  v_lshrrev_b32 v29, 8, v29
  v_lshl_add_u32 v29, v29, 7, s72
  global_load_dword v27, v29, s[74:75]
  v_and_b32_e64 v0, 63, v0
  v_readfirstlane_b32 s60, v28
  s_and_b32 s72, s2, 7
  s_and_b32 s61, s72, 1
  s_lshl_b32 s61, s61, 3
  s_and_b32 s74, s73, 7
  s_add_u32 s61, s61, s74
  s_bfe_u32 s75, s73, 0x10003
  s_and_b32 s62, s72, 6
  s_add_u32 s62, s62, s75
  v_lshlrev_b32 v1, 4, v0
  s_and_b32 s63, s60, 3
  s_lshl_b32 s66, s63, 11
  s_lshl_b32 s67, s63, 12
  s_cmp_lt_u32 s60, 4
  s_cbranch_scc0 L_l
  s_lshl2_add_u32 s65, s60, s73
  s_and_b32 s65, s65, 15
  s_max_u32 s44, s65, 11
  s_sub_u32 s44, s44, 11
  s_lshl_b32 s44, s44, 21
  s_lshl_b32 s65, s65, 2
  s_mov_b32 s74, 0x51a37510
  s_mov_b32 s75, 0xccccc370
  s_lshr_b64 s[74:75], s[74:75], s65
  s_and_b32 s74, s74, 15
  s_lshl_b32 s74, s74, 3
  s_load_dwordx2 s[32:33], s[0:1], s74
  s_lshr_b32 s74, s73, 4
  s_lshl3_add_u32 s74, s74, 64
  s_and_b32 s45, s73, 15
  s_and_b32 s75, s72, 6
  s_mul_i32 s65, s75, 43
  s_lshr_b32 s65, s65, 3
  s_add_u32 s65, s65, s45
  s_min_u32 s65, s65, 42
  s_cmp_eq_u32 s60, 2
  s_cselect_b32 s45, s65, s45
  s_cselect_b32 s74, 48, s74
  s_lshl4_add_u32 s65, s75, s73
  s_lshl1_add_u32 s65, s65, s60
  s_cmp_lt_u32 s60, 2
  s_cselect_b32 s45, s65, s45
  s_cselect_b32 s74, 16, s74
  s_load_dwordx2 s[34:35], s[0:1], s74
  s_lshl_b32 s45, s45, 6
  s_waitcnt lgkmcnt(0)
  s_load_dword s100, s[32:33], s44
  s_load_dword s101, s[34:35], s45
  s_branch L_m
L_l:
  s_lshl_b32 s70, s61, 17
  s_and_b32 s79, s73, 6
  s_add_u32 s74, s72, 1
  s_lshr_b32 s74, s74, 1
  s_add_u32 s79, s79, s74
  s_lshr_b32 s74, s73, 4
  s_lshl_b32 s74, s74, 2
  s_add_u32 s79, s79, s74
  v_lshrrev_b32 v28, 3, v0
  v_lshrrev_b32 v29, 4, v0
  v_and_b32 v30, 7, v0
  v_xor_b32 v2, v30, v29
  v_lshlrev_b32_e64 v2, 4, v2
  v_lshl_add_u32 v2, v28, 10, v2
  s_lshl_b32 s74, s63, 15
  v_add_u32 v2, s74, v2
  v_xor_b32_e64 v3, 64, v2
  v_add_u32 v3, 7168, v3
  v_add_u32 v4, 14336, v2
  v_add_u32 v5, 14336, v3
  v_and_b32 v29, 1, v29
  v_lshlrev_b32 v29, 2, v29
  v_xor_b32 v30, v30, v29
  v_lshlrev_b32 v30, 4, v30
  s_lshl_b32 s74, s63, 4
  v_add_u32 v28, s74, v28
  s_mov_b32 s34, 2097152
  s_mov_b32 s35, 0x20000
  s_mov_b32 s39, 0x20000
  s_waitcnt lgkmcnt(0)
  s_mov_b32 s32, s4
  s_mov_b32 s33, s5
  s_mov_b32 s26, s79
  s_add_u32 s27, s26, 0
  s_and_b32 s27, s27, 7
  s_add_u32 m0, s67, 73728
  s_lshl_b32 s65, s27, 7
  s_add_u32 s65, s65, s70
  buffer_load_dwordx4 v2, s[32:35], s65 offen offset:0 lds
  buffer_load_dwordx4 v3, s[32:35], s65 offen offset:1024 lds
  buffer_load_dwordx4 v4, s[32:35], s65 offen offset:2048 lds
  buffer_load_dwordx4 v5, s[32:35], s65 offen offset:3072 lds
  s_bitcmp1_b32 s73, 4
  s_cbranch_scc0 L_lq
  s_mov_b32 s36, s14
  s_mov_b32 s37, s15
  s_mov_b32 s38, 1409024
  s_movk_i32 s74, 2752
  v_mad_u32_u24 v6, v28, s74, v30
  v_add_u32 v7, 20992, v6
  v_cmp_lt_u32 vcc, 63, v30
  s_mul_i32 s74, s62, 43
  s_add_u32 s75, s74, 50
  s_lshr_b32 s75, s75, 3
  s_add_u32 s74, s74, 7
  s_lshr_b32 s74, s74, 3
  s_sub_u32 s75, s75, s74
  s_lshl_b32 s71, s74, 6
  s_cmp_eq_u32 s75, 5
  s_cselect_b32 s3, 1879048192, 0
  v_mov_b32 v29, s3
  v_cndmask_b32 v29, 0, v29, vcc
  v_add_u32 v8, v6, v29
  v_add_u32 v9, v7, v29
  s_add_u32 m0, s66, 106496
  s_mul_i32 s65, s27, 176128
  s_add_u32 s65, s65, s71
  buffer_load_dwordx4 v6, s[36:39], s65 offen offset:0 lds
  buffer_load_dwordx4 v7, s[36:39], s65 offen offset:1024 lds
  s_add_u32 m0, s66, 114688
  s_add_u32 s65, s65, 128
  buffer_load_dwordx4 v6, s[36:39], s65 offen offset:0 lds
  buffer_load_dwordx4 v7, s[36:39], s65 offen offset:1024 lds
  s_add_u32 m0, s66, 122880
  s_add_u32 s65, s65, 128
  buffer_load_dwordx4 v8, s[36:39], s65 offen offset:0 lds
  buffer_load_dwordx4 v9, s[36:39], s65 offen offset:1024 lds
  s_branch L_lf
L_lq:
  s_mov_b32 s36, s6
  s_mov_b32 s37, s7
  s_mov_b32 s38, 1572864
  s_movk_i32 s74, 3072
  v_mad_u32_u24 v6, v28, s74, v30
  v_add_u32 v7, 23552, v6
  v_add_u32 v8, 1024, v6
  v_add_u32 v9, 1024, v7
  s_lshl_b32 s71, s62, 7
  s_add_u32 m0, s66, 0
  s_mul_i32 s65, s27, 196608
  s_add_u32 s65, s65, s71
  buffer_load_dwordx4 v8, s[36:39], s65 offen offset:0 lds
  buffer_load_dwordx4 v9, s[36:39], s65 offen offset:1024 lds
  s_add_u32 m0, s66, 8192
  s_add_u32 s65, s65, 1024
  buffer_load_dwordx4 v8, s[36:39], s65 offen offset:0 lds
  buffer_load_dwordx4 v9, s[36:39], s65 offen offset:1024 lds
  s_load_dword s68, s[28:29], 0
  v_lshl_add_u32 v10, v28, 10, v30
  v_add_u32 v11, 7168, v10
  s_lshl_b32 s64, s72, 2
  s_lshr_b32 s74, s73, 3
  s_add_u32 s64, s64, s74
  s_and_b32 s74, s73, 1
  s_lshl_b32 s74, s74, 1
  s_xor_b32 s64, s64, s74
  s_and_b32 s30, s73, 7
  s_lshl_b32 s30, s30, 7
  s_mul_i32 s4, s72, 21
  s_lshr_b32 s74, s73, 0
  s_and_b32 s74, s74, 7
  s_mul_i32 s5, s74, 0
  s_add_u32 s4, s4, s5
  s_lshr_b32 s4, s4, 3
  s_cmp_ge_u32 s4, 21
  s_cselect_b32 s5, 21, 0
  s_sub_u32 s4, s4, s5
  s_mul_i32 s5, s72, 1
  s_mul_i32 s74, s74, 0
  s_add_u32 s5, s5, s74
  s_mov_b32 s40, s18
  s_mov_b32 s41, s19
  s_mov_b32 s42, 1409024
  s_mov_b32 s43, 0x20000
  s_mov_b32 s44, s10
  s_mov_b32 s45, s11
  s_mov_b32 s46, 524288
  s_mov_b32 s47, 0x20000
  s_mov_b32 s48, s28
  s_mov_b32 s49, s29
  s_mov_b32 s50, 33554432
  s_mov_b32 s51, 0x20000
  v_and_b32 v28, 3, v0
  v_lshlrev_b32 v28, 3, v28
  v_bfe_u32 v29, v0, 4, 1
  v_lshl_add_u32 v28, v29, 5, v28
  v_bfe_u32 v29, v0, 3, 1
  v_lshl_add_u32 v28, v29, 6, v28
  v_bfe_u32 v29, v0, 2, 2
  v_lshl_add_u32 v28, v29, 7, v28
  v_lshrrev_b32_e64 v29, 5, v0
  v_lshl_add_u32 v28, v29, 9, v28
  v_add_u32_e64 v12, s66, v28
  v_add_u32 v13, 0x10000, v12
  v_add_u32 v14, 0x20000, v12
  v_xor_b32_e64 v15, 64, v12
  v_add_u32 v16, 0x10000, v15
  v_add_u32 v17, 0x20000, v15
  v_lshlrev_b32 v19, 7, v0
  v_lshrrev_b32 v22, 5, v0
  v_lshlrev_b32_e64 v22, 28, v22
  v_lshl_add_u32 v22, v0, 1, v22
  s_mul_i32 s74, s64, 245760
  s_lshl_b32 s75, s63, 10
  s_add_u32 s74, s74, s75
  v_add_u32 v18, s74, v1
  v_and_b32 v28, 15, v0
  v_xor_b32 v28, v28, v29
  v_lshlrev_b32 v28, 4, v28
  v_and_b32_e64 v29, 7, v0
  v_lshl_add_u32 v28, v29, 8, v28
  v_bfe_u32 v29, v0, 3, 2
  v_lshl_add_u32 v28, v29, 13, v28
  s_add_u32 s74, s66, 40960
  v_add_u32_e64 v23, s74, v28
  s_add_u32 s27, s26, 1
  s_and_b32 s27, s27, 7
  s_add_u32 m0, s67, 90112
  s_lshl_b32 s65, s27, 7
  s_add_u32 s65, s65, s70
  buffer_load_dwordx4 v2, s[32:35], s65 offen offset:0 lds
  buffer_load_dwordx4 v3, s[32:35], s65 offen offset:1024 lds
  buffer_load_dwordx4 v4, s[32:35], s65 offen offset:2048 lds
  buffer_load_dwordx4 v5, s[32:35], s65 offen offset:3072 lds
  s_add_u32 m0, s66, 16384
  s_mul_i32 s65, s27, 196608
  s_add_u32 s65, s65, s71
  buffer_load_dwordx4 v8, s[36:39], s65 offen offset:0 lds
  buffer_load_dwordx4 v9, s[36:39], s65 offen offset:1024 lds
  s_add_u32 m0, s66, 24576
  s_add_u32 s65, s65, 1024
  buffer_load_dwordx4 v8, s[36:39], s65 offen offset:0 lds
  buffer_load_dwordx4 v9, s[36:39], s65 offen offset:1024 lds
  s_mov_b32 s56, s8
  s_mov_b32 s57, s9
  s_mov_b32 s58, 16384
  s_mov_b32 s59, 0x20000
  s_lshl_b32 s75, s63, 9
  s_add_u32 m0, s75, 155648
  s_lshl_b32 s74, s62, 11
  s_add_u32 s74, s74, s75
  s_mov_b32 exec_hi, 0
  buffer_load_dwordx4 v1, s[56:59], s74 offen lds
  s_mov_b32 exec_hi, -1
  s_waitcnt vmcnt(9) lgkmcnt(0)
  s_barrier
  s_mul_i32 s68, s68, 1664525
  s_add_u32 s68, s68, 1013904223
  s_xor_b32 s69, s68, 0x9e3779b9
  s_add_u32 s27, s26, 2
  s_and_b32 s27, s27, 7
  s_add_u32 m0, s67, 57344
  s_lshl_b32 s65, s27, 7
  s_add_u32 s65, s65, s70
  buffer_load_dwordx4 v2, s[32:35], s65 offen offset:0 lds
  buffer_load_dwordx4 v3, s[32:35], s65 offen offset:1024 lds
  buffer_load_dwordx4 v4, s[32:35], s65 offen offset:2048 lds
  buffer_load_dwordx4 v5, s[32:35], s65 offen offset:3072 lds
  s_add_u32 m0, s66, 32768
  s_mul_i32 s65, s27, 196608
  s_add_u32 s65, s65, s71
  buffer_load_dwordx4 v8, s[36:39], s65 offen offset:0 lds
  buffer_load_dwordx4 v9, s[36:39], s65 offen offset:1024 lds
  s_add_u32 m0, s66, 40960
  s_add_u32 s65, s65, 1024
  buffer_load_dwordx4 v8, s[36:39], s65 offen offset:0 lds
  buffer_load_dwordx4 v9, s[36:39], s65 offen offset:1024 lds
  s_waitcnt vmcnt(9)
  s_barrier
  s_add_u32 s27, s26, 3
  s_and_b32 s27, s27, 7
  s_add_u32 m0, s67, 73728
  s_lshl_b32 s65, s27, 7
  s_add_u32 s65, s65, s70
  buffer_load_dwordx4 v2, s[32:35], s65 offen offset:0 lds
  buffer_load_dwordx4 v3, s[32:35], s65 offen offset:1024 lds
  buffer_load_dwordx4 v4, s[32:35], s65 offen offset:2048 lds
  buffer_load_dwordx4 v5, s[32:35], s65 offen offset:3072 lds
  s_add_u32 m0, s66, 0
  s_mul_i32 s65, s27, 196608
  s_add_u32 s65, s65, s71
  buffer_load_dwordx4 v8, s[36:39], s65 offen offset:0 lds
  buffer_load_dwordx4 v9, s[36:39], s65 offen offset:1024 lds
  s_add_u32 m0, s66, 8192
  s_add_u32 s65, s65, 1024
  buffer_load_dwordx4 v8, s[36:39], s65 offen offset:0 lds
  buffer_load_dwordx4 v9, s[36:39], s65 offen offset:1024 lds
  s_waitcnt vmcnt(8)
  s_barrier
  s_add_u32 s27, s26, 4
  s_and_b32 s27, s27, 7
  s_add_u32 m0, s67, 90112
  s_lshl_b32 s65, s27, 7
  s_add_u32 s65, s65, s70
  buffer_load_dwordx4 v2, s[32:35], s65 offen offset:0 lds
  buffer_load_dwordx4 v3, s[32:35], s65 offen offset:1024 lds
  buffer_load_dwordx4 v4, s[32:35], s65 offen offset:2048 lds
  buffer_load_dwordx4 v5, s[32:35], s65 offen offset:3072 lds
  s_add_u32 m0, s66, 16384
  s_mul_i32 s65, s27, 196608
  s_add_u32 s65, s65, s71
  buffer_load_dwordx4 v8, s[36:39], s65 offen offset:0 lds
  buffer_load_dwordx4 v9, s[36:39], s65 offen offset:1024 lds
  s_add_u32 m0, s66, 24576
  s_add_u32 s65, s65, 1024
  buffer_load_dwordx4 v8, s[36:39], s65 offen offset:0 lds
  buffer_load_dwordx4 v9, s[36:39], s65 offen offset:1024 lds
  s_waitcnt vmcnt(8)
  s_barrier
  s_add_u32 s27, s26, 5
  s_and_b32 s27, s27, 7
  s_add_u32 m0, s67, 57344
  s_lshl_b32 s65, s27, 7
  s_add_u32 s65, s65, s70
  buffer_load_dwordx4 v2, s[32:35], s65 offen offset:0 lds
  buffer_load_dwordx4 v3, s[32:35], s65 offen offset:1024 lds
  buffer_load_dwordx4 v4, s[32:35], s65 offen offset:2048 lds
  buffer_load_dwordx4 v5, s[32:35], s65 offen offset:3072 lds
  s_add_u32 m0, s66, 32768
  s_mul_i32 s65, s27, 196608
  s_add_u32 s65, s65, s71
  buffer_load_dwordx4 v8, s[36:39], s65 offen offset:0 lds
  buffer_load_dwordx4 v9, s[36:39], s65 offen offset:1024 lds
  s_add_u32 m0, s66, 40960
  s_add_u32 s65, s65, 1024
  buffer_load_dwordx4 v8, s[36:39], s65 offen offset:0 lds
  buffer_load_dwordx4 v9, s[36:39], s65 offen offset:1024 lds
  s_waitcnt vmcnt(8)
  s_barrier
  s_add_u32 s27, s26, 6
  s_and_b32 s27, s27, 7
  s_add_u32 m0, s67, 73728
  s_lshl_b32 s65, s27, 7
  s_add_u32 s65, s65, s70
  buffer_load_dwordx4 v2, s[32:35], s65 offen offset:0 lds
  buffer_load_dwordx4 v3, s[32:35], s65 offen offset:1024 lds
  buffer_load_dwordx4 v4, s[32:35], s65 offen offset:2048 lds
  buffer_load_dwordx4 v5, s[32:35], s65 offen offset:3072 lds
  s_add_u32 m0, s66, 0
  s_mul_i32 s65, s27, 196608
  s_add_u32 s65, s65, s71
  buffer_load_dwordx4 v8, s[36:39], s65 offen offset:0 lds
  buffer_load_dwordx4 v9, s[36:39], s65 offen offset:1024 lds
  s_add_u32 m0, s66, 8192
  s_add_u32 s65, s65, 1024
  buffer_load_dwordx4 v8, s[36:39], s65 offen offset:0 lds
  buffer_load_dwordx4 v9, s[36:39], s65 offen offset:1024 lds
  s_waitcnt vmcnt(8)
  s_barrier
  s_add_u32 s27, s26, 7
  s_and_b32 s27, s27, 7
  s_add_u32 m0, s67, 90112
  s_lshl_b32 s65, s27, 7
  s_add_u32 s65, s65, s70
  buffer_load_dwordx4 v2, s[32:35], s65 offen offset:0 lds
  buffer_load_dwordx4 v3, s[32:35], s65 offen offset:1024 lds
  buffer_load_dwordx4 v4, s[32:35], s65 offen offset:2048 lds
  buffer_load_dwordx4 v5, s[32:35], s65 offen offset:3072 lds
  s_add_u32 m0, s66, 16384
  s_mul_i32 s65, s27, 196608
  s_add_u32 s65, s65, s71
  buffer_load_dwordx4 v8, s[36:39], s65 offen offset:0 lds
  buffer_load_dwordx4 v9, s[36:39], s65 offen offset:1024 lds
  s_add_u32 m0, s66, 24576
  s_add_u32 s65, s65, 1024
  buffer_load_dwordx4 v8, s[36:39], s65 offen offset:0 lds
  buffer_load_dwordx4 v9, s[36:39], s65 offen offset:1024 lds
  s_waitcnt vmcnt(8)
  s_barrier
  s_add_u32 s27, s26, 0
  s_and_b32 s27, s27, 7
  s_add_u32 m0, s66, 106496
  s_mul_i32 s65, s27, 196608
  s_add_u32 s65, s65, s71
  buffer_load_dwordx4 v6, s[36:39], s65 offen offset:0 lds
  buffer_load_dwordx4 v7, s[36:39], s65 offen offset:1024 lds
  s_add_u32 s27, s26, 1
  s_and_b32 s27, s27, 7
  s_add_u32 m0, s66, 114688
  s_mul_i32 s65, s27, 196608
  s_add_u32 s65, s65, s71
  buffer_load_dwordx4 v6, s[36:39], s65 offen offset:0 lds
  buffer_load_dwordx4 v7, s[36:39], s65 offen offset:1024 lds
  s_add_u32 s27, s26, 2
  s_and_b32 s27, s27, 7
  s_add_u32 m0, s66, 122880
  s_mul_i32 s65, s27, 196608
  s_add_u32 s65, s65, s71
  buffer_load_dwordx4 v6, s[36:39], s65 offen offset:0 lds
  buffer_load_dwordx4 v7, s[36:39], s65 offen offset:1024 lds
  s_add_u32 s27, s26, 3
  s_and_b32 s27, s27, 7
  s_add_u32 m0, s66, 131072
  s_mul_i32 s65, s27, 196608
  s_add_u32 s65, s65, s71
  buffer_load_dwordx4 v6, s[36:39], s65 offen offset:0 lds
  buffer_load_dwordx4 v7, s[36:39], s65 offen offset:1024 lds
  v_lshrrev_b32_e64 v29, 5, v0
  v_bfe_u32 v28, v0, 2, 1
  v_cmp_eq_u32 s[76:77], v28, v29
  v_bfe_u32 v28, v0, 3, 2
  v_lshlrev_b32_e64 v28, 1, v28
  v_bfe_u32 v29, v0, 1, 1
  v_add_u32 v28, v28, v29
  v_and_b32 v29, 1, v0
  v_lshlrev_b32_e64 v29, 4, v29
  v_mov_b32 v30, 0x3f80
  v_lshlrev_b32_e64 v30, v29, v30
  v_cndmask_b32 v30, 0, v30, s[76:77]
  v_cmp_eq_u32 vcc, 0, v28
  s_nop 1
  v_cndmask_b32 v2, 0, v30, vcc
  v_cmp_eq_u32 vcc, 1, v28
  s_nop 1
  v_cndmask_b32 v3, 0, v30, vcc
  v_cmp_eq_u32 vcc, 2, v28
  s_nop 1
  v_cndmask_b32 v4, 0, v30, vcc
  v_cmp_eq_u32 vcc, 3, v28
  s_nop 1
  v_cndmask_b32 v5, 0, v30, vcc
  s_lshl2_add_u32 s72, s2, s63
  s_lshl_b32 s73, s72, 10
  s_mul_i32 s72, s72, 2816
  s_mov_b64 exec, 0xff
  buffer_load_dword v27, v19, s[44:47], s73 offen
  s_mov_b64 exec, -1
  s_waitcnt vmcnt(9)
  s_barrier
  s_lshr_b32 s72, s2, 3
  s_lshl2_add_u32 s72, s72, s63
  s_lshl_b32 s72, s72, 15
  s_add_u32 s72, s72, 384
  s_sub_u32 s73, s72, 1409024
  v_lshlrev_b32 v28, 10, v0
  s_mov_b32 exec_hi, 0
  buffer_load_dword v27, v28, s[40:43], s72 offen
  buffer_load_dword v27, v28, s[44:47], s73 offen
  s_mov_b32 exec_hi, -1
  s_barrier
  s_add_u32 s27, s26, 4
  s_and_b32 s27, s27, 7
  s_add_u32 m0, s66, 139264
  s_mul_i32 s65, s27, 196608
  s_add_u32 s65, s65, s71
  buffer_load_dwordx4 v6, s[36:39], s65 offen offset:0 lds
  buffer_load_dwordx4 v7, s[36:39], s65 offen offset:1024 lds
  s_add_u32 s27, s26, 5
  s_and_b32 s27, s27, 7
  s_add_u32 m0, s66, 147456
  s_mul_i32 s65, s27, 196608
  s_add_u32 s65, s65, s71
  buffer_load_dwordx4 v6, s[36:39], s65 offen offset:0 lds
  buffer_load_dwordx4 v7, s[36:39], s65 offen offset:1024 lds
  s_add_u32 s27, s26, 6
  s_and_b32 s27, s27, 7
  s_add_u32 m0, s66, 90112
  s_mul_i32 s65, s27, 196608
  s_add_u32 s65, s65, s71
  buffer_load_dwordx4 v6, s[36:39], s65 offen offset:0 lds
  buffer_load_dwordx4 v7, s[36:39], s65 offen offset:1024 lds
  s_add_u32 s27, s26, 7
  s_and_b32 s27, s27, 7
  s_add_u32 m0, s66, 98304
  s_mul_i32 s65, s27, 196608
  s_add_u32 s65, s65, s71
  buffer_load_dwordx4 v6, s[36:39], s65 offen offset:0 lds
  buffer_load_dwordx4 v7, s[36:39], s65 offen offset:1024 lds
  s_add_u32 m0, s66, 49152
  s_cmp_ge_u32 s4, 21
  s_cselect_b32 s65, -21, 0
  s_add_u32 s65, s65, s4
  s_lshl_b32 s65, s65, 16
  s_add_u32 s65, s65, s30
  buffer_load_dwordx4 v10, s[40:43], s65 offen offset:0 lds
  buffer_load_dwordx4 v11, s[40:43], s65 offen offset:1024 lds
  s_add_u32 m0, s66, 32768
  s_cmp_ge_u32 s4, 20
  s_cselect_b32 s65, -20, 1
  s_add_u32 s65, s65, s4
  s_lshl_b32 s65, s65, 16
  s_add_u32 s65, s65, s30
  buffer_load_dwordx4 v10, s[40:43], s65 offen offset:0 lds
  buffer_load_dwordx4 v11, s[40:43], s65 offen offset:1024 lds
  s_add_u32 m0, s66, 40960
  s_cmp_ge_u32 s4, 19
  s_cselect_b32 s65, -19, 2
  s_add_u32 s65, s65, s4
  s_lshl_b32 s65, s65, 16
  s_add_u32 s65, s65, s30
  buffer_load_dwordx4 v10, s[40:43], s65 offen offset:0 lds
  buffer_load_dwordx4 v11, s[40:43], s65 offen offset:1024 lds
  s_add_u32 m0, s66, 0
  s_cmp_ge_u32 s4, 18
  s_cselect_b32 s65, -18, 3
  s_add_u32 s65, s65, s4
  s_lshl_b32 s65, s65, 16
  s_add_u32 s65, s65, s30
  buffer_load_dwordx4 v10, s[40:43], s65 offen offset:0 lds
  buffer_load_dwordx4 v11, s[40:43], s65 offen offset:1024 lds
  s_add_u32 m0, s66, 8192
  s_cmp_ge_u32 s4, 17
  s_cselect_b32 s65, -17, 4
  s_add_u32 s65, s65, s4
  s_lshl_b32 s65, s65, 16
  s_add_u32 s65, s65, s30
  s_waitcnt vmcnt(6)
  buffer_load_dwordx4 v10, s[40:43], s65 offen offset:0 lds
  buffer_load_dwordx4 v11, s[40:43], s65 offen offset:1024 lds
  ds_read_b64_tr_b16 v[144:145], v12 offset:49152
  ds_read_b64_tr_b16 v[146:147], v12 offset:50176
  ds_read_b64_tr_b16 v[148:149], v15 offset:49152
  ds_read_b64_tr_b16 v[150:151], v15 offset:50176
  v_and_b32 v28, 3, v0
  v_lshlrev_b32 v28, 1, v28
  v_bfe_u32 v29, v0, 3, 2
  v_xor_b32 v28, v28, v29
  v_and_b32 v29, 4, v0
  v_xor_b32 v28, v28, v29
  v_lshlrev_b32 v28, 4, v28
  v_lshrrev_b32_e64 v29, 2, v0
  v_lshl_add_u32 v28, v29, 7, v28
  s_add_u32 s72, s66, 57344
  v_add_u32 v28, s72, v28
  v_xor_b32 v29, 16, v28
  v_and_b32 v30, 15, v0
  s_lshl_b32 s75, s63, 7
  s_add_u32 s73, s75, 161792
  v_lshl_add_u32 v30, v30, 3, s73
  s_lshl_b32 s72, s62, 4
  s_add_u32 s72, s72, s61
  s_mul_i32 s72, s72, 4608
  s_add_u32 s72, s72, 262144
  s_add_u32 s75, s75, s72
  s_add_u32 s75, s75, 4096
  s_lshl_b32 s74, s63, 10
  s_add_u32 s72, s72, s74
  v_lshlrev_b32 v31, 2, v0
  s_lshl_b32 s12, s62, 13
  s_add_u32 s12, s12, s66
  s_add_u32 s12, s12, 65536
  s_setprio 2
  s_barrier
  ds_read_b128 v[32:35], v28 offset:0
  ds_read_b128 v[36:39], v29 offset:0
  ds_read_b128 v[40:43], v28 offset:8192
  ds_read_b128 v[44:47], v29 offset:8192
  ds_read_b128 v[48:51], v28 offset:16384
  ds_read_b128 v[52:55], v29 offset:16384
  ds_read_b128 v[56:59], v28 offset:24576
  ds_read_b128 v[60:63], v29 offset:24576
  ds_read_b64 v[64:65], v30 offset:0
  ds_read_b64 v[66:67], v30 offset:512
  ds_read_b64 v[68:69], v30 offset:1024
  ds_read_b64 v[70:71], v30 offset:1536
  s_waitcnt lgkmcnt(8)
  v_add_f32 v32, v32, v40
  v_add_f32 v33, v33, v41
  v_add_f32 v34, v34, v42
  v_add_f32 v35, v35, v43
  v_add_f32 v36, v36, v44
  v_add_f32 v37, v37, v45
  v_add_f32 v38, v38, v46
  v_add_f32 v39, v39, v47
  s_waitcnt lgkmcnt(6)
  v_add_f32 v32, v32, v48
  v_add_f32 v33, v33, v49
  v_add_f32 v34, v34, v50
  v_add_f32 v35, v35, v51
  v_add_f32 v36, v36, v52
  v_add_f32 v37, v37, v53
  v_add_f32 v38, v38, v54
  v_add_f32 v39, v39, v55
  s_waitcnt lgkmcnt(4)
  v_add_f32 v32, v32, v56
  v_add_f32 v33, v33, v57
  v_add_f32 v34, v34, v58
  v_add_f32 v35, v35, v59
  v_add_f32 v36, v36, v60
  v_add_f32 v37, v37, v61
  v_add_f32 v38, v38, v62
  v_add_f32_e64 v39, v39, v63
  v_cvt_pk_bf16_f32 v40, v32, v33
  v_cvt_pk_bf16_f32 v41, v34, v35
  v_cvt_pk_bf16_f32 v42, v36, v37
  v_cvt_pk_bf16_f32 v43, v38, v39
  buffer_store_dwordx4 v[40:43], v1, s[48:51], s72 offen sc1
  s_waitcnt lgkmcnt(0)
  v_add_f32 v64, v64, v68
  v_add_f32 v65, v65, v69
  v_add_f32 v66, v66, v70
  v_add_f32 v67, v67, v71
  v_add_f32 v64, v64, v66
  v_add_f32_e64 v65, v65, v67
  v_cvt_pk_bf16_f32 v64, v64, v65
  s_mov_b32 exec_hi, 0
  buffer_store_dword v64, v31, s[48:51], s75 offen sc1
  s_mov_b32 exec_hi, -1
  s_add_u32 m0, s66, 16384
  s_cmp_ge_u32 s4, 16
  s_cselect_b32 s65, -16, 5
  s_add_u32 s65, s65, s4
  s_lshl_b32 s65, s65, 16
  s_add_u32 s65, s65, s30
  s_waitcnt vmcnt(8)
  buffer_load_dwordx4 v10, s[40:43], s65 offen offset:0 lds
  buffer_load_dwordx4 v11, s[40:43], s65 offen offset:1024 lds
  ds_read_b64_tr_b16 v[152:153], v12 offset:32768
  ds_read_b64_tr_b16 v[154:155], v12 offset:33792
  ds_read_b64_tr_b16 v[156:157], v15 offset:32768
  ds_read_b64_tr_b16 v[158:159], v15 offset:33792
  s_add_u32 m0, s66, 24576
  s_cmp_ge_u32 s4, 15
  s_cselect_b32 s65, -15, 6
  s_add_u32 s65, s65, s4
  s_lshl_b32 s65, s65, 16
  s_add_u32 s65, s65, s30
  s_waitcnt vmcnt(8)
  buffer_load_dwordx4 v10, s[40:43], s65 offen offset:0 lds
  buffer_load_dwordx4 v11, s[40:43], s65 offen offset:1024 lds
  ds_read_b64_tr_b16 v[160:161], v12 offset:40960
  ds_read_b64_tr_b16 v[162:163], v12 offset:41984
  ds_read_b64_tr_b16 v[164:165], v15 offset:40960
  ds_read_b64_tr_b16 v[166:167], v15 offset:41984
  s_add_u32 m0, s66, 49152
  s_cmp_ge_u32 s4, 14
  s_cselect_b32 s65, -14, 7
  s_add_u32 s65, s65, s4
  s_lshl_b32 s65, s65, 16
  s_add_u32 s65, s65, s30
  s_waitcnt vmcnt(8)
  buffer_load_dwordx4 v10, s[40:43], s65 offen offset:0 lds
  buffer_load_dwordx4 v11, s[40:43], s65 offen offset:1024 lds
  ds_read_b64_tr_b16 v[168:169], v12 offset:0
  ds_read_b64_tr_b16 v[170:171], v12 offset:1024
  ds_read_b64_tr_b16 v[172:173], v15 offset:0
  ds_read_b64_tr_b16 v[174:175], v15 offset:1024
  s_waitcnt lgkmcnt(8)
  s_add_u32 m0, s66, 32768
  s_cmp_ge_u32 s4, 13
  s_cselect_b32 s65, -13, 8
  s_add_u32 s65, s65, s4
  s_lshl_b32 s65, s65, 16
  s_add_u32 s65, s65, s30
  s_waitcnt vmcnt(8)
  buffer_load_dwordx4 v10, s[40:43], s65 offen offset:0 lds
  buffer_load_dwordx4 v11, s[40:43], s65 offen offset:1024 lds
  ds_read_b64_tr_b16 v[176:177], v12 offset:8192
  ds_read_b64_tr_b16 v[178:179], v12 offset:9216
  ds_read_b64_tr_b16 v[180:181], v15 offset:8192
  ds_read_b64_tr_b16 v[182:183], v15 offset:9216
  s_lshl_b32 s73, s61, 7
  s_add_u32 s73, s73, s12
  s_waitcnt vmcnt(8)
  v_mov_b32 v28, s68
  v_mov_b32 v29, s69
  v_lshrrev_b32_e64 v30, 1, v1
  s_mov_b64 exec, 0xffff
  buffer_store_dwordx2 v[28:29], v30, s[48:51], s73 offen sc1
  s_mov_b64 exec, -1
  s_waitcnt lgkmcnt(8)
  s_add_u32 m0, s66, 40960
  s_cmp_ge_u32 s4, 12
  s_cselect_b32 s65, -12, 9
  s_add_u32 s65, s65, s4
  s_lshl_b32 s65, s65, 16
  s_add_u32 s65, s65, s30
  s_waitcnt vmcnt(7)
  buffer_load_dwordx4 v10, s[40:43], s65 offen offset:0 lds
  buffer_load_dwordx4 v11, s[40:43], s65 offen offset:1024 lds
  ds_read_b64_tr_b16 v[184:185], v12 offset:16384
  ds_read_b64_tr_b16 v[186:187], v12 offset:17408
  ds_read_b64_tr_b16 v[188:189], v15 offset:16384
  ds_read_b64_tr_b16 v[190:191], v15 offset:17408
  s_waitcnt lgkmcnt(8)
  s_add_u32 m0, s66, 0
  s_cmp_ge_u32 s4, 11
  s_cselect_b32 s65, -11, 10
  s_add_u32 s65, s65, s4
  s_lshl_b32 s65, s65, 16
  s_add_u32 s65, s65, s30
  s_waitcnt vmcnt(7)
  buffer_load_dwordx4 v10, s[40:43], s65 offen offset:0 lds
  buffer_load_dwordx4 v11, s[40:43], s65 offen offset:1024 lds
  ds_read_b64_tr_b16 v[192:193], v12 offset:24576
  ds_read_b64_tr_b16 v[194:195], v12 offset:25600
  ds_read_b64_tr_b16 v[196:197], v15 offset:24576
  ds_read_b64_tr_b16 v[198:199], v15 offset:25600
  s_waitcnt lgkmcnt(8)
  s_add_u32 m0, s66, 8192
  s_cmp_ge_u32 s4, 10
  s_cselect_b32 s65, -10, 11
  s_add_u32 s65, s65, s4
  s_lshl_b32 s65, s65, 16
  s_add_u32 s65, s65, s30
  s_waitcnt vmcnt(7)
  buffer_load_dwordx4 v10, s[40:43], s65 offen offset:0 lds
  buffer_load_dwordx4 v11, s[40:43], s65 offen offset:1024 lds
  ds_read_b64_tr_b16 v[200:201], v12 offset:49152
  ds_read_b64_tr_b16 v[202:203], v12 offset:50176
  ds_read_b64_tr_b16 v[204:205], v15 offset:49152
  ds_read_b64_tr_b16 v[206:207], v15 offset:50176
  s_waitcnt lgkmcnt(8)
  s_add_u32 m0, s66, 16384
  s_cmp_ge_u32 s4, 9
  s_cselect_b32 s65, -9, 12
  s_add_u32 s65, s65, s4
  s_lshl_b32 s65, s65, 16
  s_add_u32 s65, s65, s30
  s_waitcnt vmcnt(7)
  buffer_load_dwordx4 v10, s[40:43], s65 offen offset:0 lds
  buffer_load_dwordx4 v11, s[40:43], s65 offen offset:1024 lds
  ds_read_b64_tr_b16 v[208:209], v12 offset:32768
  ds_read_b64_tr_b16 v[210:211], v12 offset:33792
  ds_read_b64_tr_b16 v[212:213], v15 offset:32768
  ds_read_b64_tr_b16 v[214:215], v15 offset:33792
  s_waitcnt lgkmcnt(8)
  s_add_u32 m0, s66, 24576
  s_cmp_ge_u32 s4, 8
  s_cselect_b32 s65, -8, 13
  s_add_u32 s65, s65, s4
  s_lshl_b32 s65, s65, 16
  s_add_u32 s65, s65, s30
  s_waitcnt vmcnt(6)
  buffer_load_dwordx4 v10, s[40:43], s65 offen offset:0 lds
  buffer_load_dwordx4 v11, s[40:43], s65 offen offset:1024 lds
  ds_read_b64_tr_b16 v[216:217], v12 offset:40960
  ds_read_b64_tr_b16 v[218:219], v12 offset:41984
  ds_read_b64_tr_b16 v[220:221], v15 offset:40960
  ds_read_b64_tr_b16 v[222:223], v15 offset:41984
  s_add_u32 m0, s66, 57344
  s_cmp_ge_u32 s4, 7
  s_cselect_b32 s65, -7, 14
  s_add_u32 s65, s65, s4
  s_lshl_b32 s65, s65, 16
  s_add_u32 s65, s65, s30
  s_waitcnt vmcnt(6)
  buffer_load_dwordx4 v10, s[40:43], s65 offen offset:0 lds
  buffer_load_dwordx4 v11, s[40:43], s65 offen offset:1024 lds
  ds_read_b64_tr_b16 v[224:225], v12 offset:0
  ds_read_b64_tr_b16 v[226:227], v12 offset:1024
  ds_read_b64_tr_b16 v[228:229], v15 offset:0
  ds_read_b64_tr_b16 v[230:231], v15 offset:1024
  s_add_u32 m0, s66, 65536
  s_cmp_ge_u32 s4, 6
  s_cselect_b32 s65, -6, 15
  s_add_u32 s65, s65, s4
  s_lshl_b32 s65, s65, 16
  s_add_u32 s65, s65, s30
  s_waitcnt vmcnt(6)
  buffer_load_dwordx4 v10, s[40:43], s65 offen offset:0 lds
  buffer_load_dwordx4 v11, s[40:43], s65 offen offset:1024 lds
  ds_read_b64_tr_b16 v[232:233], v12 offset:8192
  ds_read_b64_tr_b16 v[234:235], v12 offset:9216
  ds_read_b64_tr_b16 v[236:237], v15 offset:8192
  ds_read_b64_tr_b16 v[238:239], v15 offset:9216
  s_mov_b64 exec, 65535
  buffer_load_dwordx2 v[20:21], v19, s[48:51], s12 offen sc1
  s_mov_b64 exec, -1
  s_add_u32 m0, s66, 73728
  s_cmp_ge_u32 s4, 5
  s_cselect_b32 s65, -5, 16
  s_add_u32 s65, s65, s4
  s_lshl_b32 s65, s65, 16
  s_add_u32 s65, s65, s30
  s_waitcnt vmcnt(7)
  buffer_load_dwordx4 v10, s[40:43], s65 offen offset:0 lds
  buffer_load_dwordx4 v11, s[40:43], s65 offen offset:1024 lds
  ds_read_b64_tr_b16 v[240:241], v12 offset:16384
  ds_read_b64_tr_b16 v[242:243], v12 offset:17408
  ds_read_b64_tr_b16 v[244:245], v15 offset:16384
  ds_read_b64_tr_b16 v[246:247], v15 offset:17408
  s_waitcnt lgkmcnt(15)
  s_add_u32 m0, s66, 49152
  s_cmp_ge_u32 s4, 4
  s_cselect_b32 s65, -4, 17
  s_add_u32 s65, s65, s4
  s_lshl_b32 s65, s65, 16
  s_add_u32 s65, s65, s30
  s_waitcnt vmcnt(7)
  buffer_load_dwordx4 v10, s[40:43], s65 offen offset:0 lds
  buffer_load_dwordx4 v11, s[40:43], s65 offen offset:1024 lds
  ds_read_b64_tr_b16 v[248:249], v12 offset:24576
  ds_read_b64_tr_b16 v[250:251], v12 offset:25600
  ds_read_b64_tr_b16 v[252:253], v15 offset:24576
  ds_read_b64_tr_b16 v[254:255], v15 offset:25600
  s_waitcnt lgkmcnt(15)
  s_add_u32 m0, s66, 40960
  s_cmp_ge_u32 s4, 3
  s_cselect_b32 s65, -3, 18
  s_add_u32 s65, s65, s4
  s_lshl_b32 s65, s65, 16
  s_add_u32 s65, s65, s30
  s_waitcnt vmcnt(7)
  buffer_load_dwordx4 v10, s[40:43], s65 offen offset:0 lds
  buffer_load_dwordx4 v11, s[40:43], s65 offen offset:1024 lds
  v_lshrrev_b32_e64 v30, 2, v0
  v_mul_u32_u24 v30, 4544, v30
  v_add_u32_e64 v30, v30, v1
  s_mul_i32 s72, s62, 73728
  s_add_u32 s72, s72, 262144
  s_lshl_b32 s73, s63, 7
  s_add_u32 s73, s73, s72
  s_add_u32 s73, s73, 4096
  s_lshl_b32 s74, s63, 10
  s_add_u32 s72, s72, s74
  v_and_b32 v29, 0x30, v0
  v_xor_b32 v29, v29, v1
  s_add_u32 s74, s66, 81920
  v_add_u32 v29, s74, v29
  s_mov_b32 s79, 0
  s_mov_b64 exec, 65535
  s_waitcnt vmcnt(6)
L_poll1:
  v_cmp_ne_u64_e64 vcc, s[68:69], v[20:21]
  s_cbranch_vccz L_pollx2
  buffer_load_dwordx2 v[20:21], v19, s[48:51], s12 offen sc1
  s_add_u32 s79, s79, 1
  s_cmp_lt_u32 s79, 0x40000
  s_waitcnt vmcnt(0)
  s_cbranch_scc1 L_poll1
L_pollx2:
  s_mov_b64 exec, -1
  buffer_load_dwordx4 v[96:99], v30, s[48:51], s73 offen sc1
  s_lshl1_add_u32 s74, s61, 0
  s_and_b32 s74, s74, 15
  s_mul_i32 s74, s74, 4608
  s_add_u32 s74, s74, s72
  buffer_load_dwordx4 v[32:35], v1, s[48:51], s74 offen sc1
  s_lshl1_add_u32 s74, s61, 1
  s_and_b32 s74, s74, 15
  s_mul_i32 s74, s74, 4608
  s_add_u32 s74, s74, s72
  buffer_load_dwordx4 v[36:39], v1, s[48:51], s74 offen sc1
  s_lshl1_add_u32 s74, s61, 2
  s_and_b32 s74, s74, 15
  s_mul_i32 s74, s74, 4608
  s_add_u32 s74, s74, s72
  buffer_load_dwordx4 v[40:43], v1, s[48:51], s74 offen sc1
  s_lshl1_add_u32 s74, s61, 3
  s_and_b32 s74, s74, 15
  s_mul_i32 s74, s74, 4608
  s_add_u32 s74, s74, s72
  buffer_load_dwordx4 v[44:47], v1, s[48:51], s74 offen sc1
  s_lshl1_add_u32 s74, s61, 4
  s_and_b32 s74, s74, 15
  s_mul_i32 s74, s74, 4608
  s_add_u32 s74, s74, s72
  buffer_load_dwordx4 v[48:51], v1, s[48:51], s74 offen sc1
  s_lshl1_add_u32 s74, s61, 5
  s_and_b32 s74, s74, 15
  s_mul_i32 s74, s74, 4608
  s_add_u32 s74, s74, s72
  buffer_load_dwordx4 v[52:55], v1, s[48:51], s74 offen sc1
  s_lshl1_add_u32 s74, s61, 6
  s_and_b32 s74, s74, 15
  s_mul_i32 s74, s74, 4608
  s_add_u32 s74, s74, s72
  buffer_load_dwordx4 v[56:59], v1, s[48:51], s74 offen sc1
  s_lshl1_add_u32 s74, s61, 7
  s_and_b32 s74, s74, 15
  s_mul_i32 s74, s74, 4608
  s_add_u32 s74, s74, s72
  buffer_load_dwordx4 v[60:63], v1, s[48:51], s74 offen sc1
  s_lshl1_add_u32 s74, s61, 8
  s_and_b32 s74, s74, 15
  s_mul_i32 s74, s74, 4608
  s_add_u32 s74, s74, s72
  buffer_load_dwordx4 v[64:67], v1, s[48:51], s74 offen sc1
  s_lshl1_add_u32 s74, s61, 9
  s_and_b32 s74, s74, 15
  s_mul_i32 s74, s74, 4608
  s_add_u32 s74, s74, s72
  buffer_load_dwordx4 v[68:71], v1, s[48:51], s74 offen sc1
  s_waitcnt vmcnt(9)
  v_mfma_f32_32x32x16_bf16 v[100:115], v[2:5], v[32:35], 0
  s_lshl1_add_u32 s74, s61, 10
  s_and_b32 s74, s74, 15
  s_mul_i32 s74, s74, 4608
  s_add_u32 s74, s74, s72
  buffer_load_dwordx4 v[72:75], v1, s[48:51], s74 offen sc1
  s_waitcnt vmcnt(9)
  v_mfma_f32_32x32x16_bf16 v[100:115], v[2:5], v[36:39], v[100:115]
  s_lshl1_add_u32 s74, s61, 11
  s_and_b32 s74, s74, 15
  s_mul_i32 s74, s74, 4608
  s_add_u32 s74, s74, s72
  buffer_load_dwordx4 v[76:79], v1, s[48:51], s74 offen sc1
  s_waitcnt vmcnt(9)
  v_mfma_f32_32x32x16_bf16 v[100:115], v[2:5], v[40:43], v[100:115]
  s_lshl1_add_u32 s74, s61, 12
  s_and_b32 s74, s74, 15
  s_mul_i32 s74, s74, 4608
  s_add_u32 s74, s74, s72
  buffer_load_dwordx4 v[80:83], v1, s[48:51], s74 offen sc1
  s_waitcnt vmcnt(9)
  v_mfma_f32_32x32x16_bf16 v[100:115], v[2:5], v[44:47], v[100:115]
  s_lshl1_add_u32 s74, s61, 13
  s_and_b32 s74, s74, 15
  s_mul_i32 s74, s74, 4608
  s_add_u32 s74, s74, s72
  buffer_load_dwordx4 v[84:87], v1, s[48:51], s74 offen sc1
  s_waitcnt vmcnt(9)
  v_mfma_f32_32x32x16_bf16 v[100:115], v[2:5], v[48:51], v[100:115]
  s_lshl1_add_u32 s74, s61, 14
  s_and_b32 s74, s74, 15
  s_mul_i32 s74, s74, 4608
  s_add_u32 s74, s74, s72
  buffer_load_dwordx4 v[88:91], v1, s[48:51], s74 offen sc1
  s_waitcnt vmcnt(9)
  v_mfma_f32_32x32x16_bf16 v[100:115], v[2:5], v[52:55], v[100:115]
  s_lshl1_add_u32 s74, s61, 15
  s_and_b32 s74, s74, 15
  s_mul_i32 s74, s74, 4608
  s_add_u32 s74, s74, s72
  buffer_load_dwordx4 v[92:95], v1, s[48:51], s74 offen sc1
  s_waitcnt vmcnt(9)
  v_mfma_f32_32x32x16_bf16 v[100:115], v[2:5], v[56:59], v[100:115]
  ds_write_b128 v29, v[96:99] offset:1024
  s_waitcnt vmcnt(8)
  v_mfma_f32_32x32x16_bf16 v[100:115], v[2:5], v[60:63], v[100:115]
  s_waitcnt vmcnt(7)
  v_mfma_f32_32x32x16_bf16 v[100:115], v[2:5], v[64:67], v[100:115]
  s_waitcnt vmcnt(6)
  v_mfma_f32_32x32x16_bf16 v[100:115], v[2:5], v[68:71], v[100:115]
  s_waitcnt vmcnt(5)
  v_mfma_f32_32x32x16_bf16 v[100:115], v[2:5], v[72:75], v[100:115]
  s_waitcnt vmcnt(4)
  v_mfma_f32_32x32x16_bf16 v[100:115], v[2:5], v[76:79], v[100:115]
  s_waitcnt vmcnt(3)
  v_mfma_f32_32x32x16_bf16 v[100:115], v[2:5], v[80:83], v[100:115]
  s_waitcnt vmcnt(2)
  v_mfma_f32_32x32x16_bf16 v[100:115], v[2:5], v[84:87], v[100:115]
  s_waitcnt vmcnt(1)
  v_mfma_f32_32x32x16_bf16 v[100:115], v[2:5], v[88:91], v[100:115]
  s_waitcnt vmcnt(0)
  v_mfma_f32_32x32x16_bf16 v[100:115], v[2:5], v[92:95], v[100:115]
  s_nop 11
  v_cvt_pk_bf16_f32 v108, v100, v101
  v_cvt_pk_bf16_f32 v109, v102, v103
  v_cvt_pk_bf16_f32 v110, v104, v105
  v_cvt_pk_bf16_f32 v111, v106, v107
  ds_write_b128 v29, v[108:111]
  s_add_u32 m0, s66, 32768
  s_add_u32 s65, s5, 0
  s_and_b32 s65, s65, 7
  s_lshl_b32 s65, s65, 16
  s_add_u32 s65, s65, s30
  buffer_load_dwordx4 v10, s[44:47], s65 offen offset:0 lds
  buffer_load_dwordx4 v11, s[44:47], s65 offen offset:1024 lds
  s_waitcnt lgkmcnt(14)
  s_add_u32 m0, s66, 0
  s_add_u32 s65, s5, 1
  s_and_b32 s65, s65, 7
  s_lshl_b32 s65, s65, 16
  s_add_u32 s65, s65, s30
  buffer_load_dwordx4 v10, s[44:47], s65 offen offset:0 lds
  buffer_load_dwordx4 v11, s[44:47], s65 offen offset:1024 lds
  s_waitcnt lgkmcnt(0)
  s_setprio 0
  s_barrier
  s_add_u32 m0, s66, 8192
  s_add_u32 s65, s5, 2
  s_and_b32 s65, s65, 7
  s_lshl_b32 s65, s65, 16
  s_add_u32 s65, s65, s30
  buffer_load_dwordx4 v10, s[44:47], s65 offen offset:0 lds
  buffer_load_dwordx4 v11, s[44:47], s65 offen offset:1024 lds
  s_add_u32 m0, s66, 16384
  s_add_u32 s65, s5, 3
  s_and_b32 s65, s65, 7
  s_lshl_b32 s65, s65, 16
  s_add_u32 s65, s65, s30
  buffer_load_dwordx4 v10, s[44:47], s65 offen offset:0 lds
  buffer_load_dwordx4 v11, s[44:47], s65 offen offset:1024 lds
  s_barrier
  s_add_u32 m0, s66, 24576
  s_add_u32 s65, s5, 4
  s_and_b32 s65, s65, 7
  s_lshl_b32 s65, s65, 16
  s_add_u32 s65, s65, s30
  s_waitcnt vmcnt(6)
  buffer_load_dwordx4 v10, s[44:47], s65 offen offset:0 lds
  buffer_load_dwordx4 v11, s[44:47], s65 offen offset:1024 lds
  s_add_u32 m0, s66, 90112
  s_cmp_ge_u32 s4, 2
  s_cselect_b32 s65, -2, 19
  s_add_u32 s65, s65, s4
  s_lshl_b32 s65, s65, 16
  s_add_u32 s65, s65, s30
  s_waitcnt vmcnt(6)
  buffer_load_dwordx4 v10, s[40:43], s65 offen offset:0 lds
  buffer_load_dwordx4 v11, s[40:43], s65 offen offset:1024 lds
  s_add_u32 m0, s66, 98304
  s_cmp_ge_u32 s4, 1
  s_cselect_b32 s65, -1, 20
  s_add_u32 s65, s65, s4
  s_lshl_b32 s65, s65, 16
  s_add_u32 s65, s65, s30
  s_waitcnt vmcnt(6)
  buffer_load_dwordx4 v10, s[40:43], s65 offen offset:0 lds
  buffer_load_dwordx4 v11, s[40:43], s65 offen offset:1024 lds
  s_mov_b32 s56, s20
  s_mov_b32 s57, s21
  s_mov_b32 s58, 1024
  s_mov_b32 s59, 0x20000
  s_cmp_lg_u32 s63, 0
  s_cselect_b32 s72, 1879048192, 0
  s_add_u32 s72, s72, s30
  buffer_load_ushort v132, v22, s[56:59], s72 offen offset:0
  v_mov_b32 v133, 0
  v_mov_b32 v134, 0
  v_mov_b32_e64 v135, 0
  buffer_load_ushort v136, v22, s[56:59], s72 offen offset:64
  v_mov_b32 v137, 0
  v_mov_b32 v138, 0
  v_mov_b32_e64 v139, 0
  v_mov_b32 v140, 0x3f803f80
  v_mov_b32 v141, 0x3f803f80
  v_mov_b32 v142, 0x3f803f80
  v_mov_b32 v143, 0x3f803f80
  s_cmp_ge_u32 s63, 2
  s_cselect_b32 s3, 1879048192, 0
  s_add_u32 s3, s3, 86016
  s_lshl_b32 s12, s64, 12
  s_add_u32 s12, s12, 851968
  s_mov_b64 exec, 65535
  buffer_load_dwordx2 v[20:21], v19, s[48:51], s12 offen sc1
  s_mov_b64 exec, -1
  s_add_u32 m0, s66, 139264
  s_mov_b32 s65, 1376256
  s_add_u32 s65, s65, s30
  s_waitcnt vmcnt(9)
  buffer_load_dwordx4 v10, s[40:43], s65 offen offset:0 lds
  buffer_load_dwordx4 v11, s[40:43], s65 offen offset:1024 lds
  s_add_u32 m0, s66, 106496
  s_add_u32 s65, s5, 5
  s_and_b32 s65, s65, 7
  s_lshl_b32 s65, s65, 16
  s_add_u32 s65, s65, s30
  s_waitcnt vmcnt(9)
  buffer_load_dwordx4 v10, s[44:47], s65 offen offset:0 lds
  buffer_load_dwordx4 v11, s[44:47], s65 offen offset:1024 lds
  s_add_u32 m0, s66, 114688
  s_add_u32 s65, s5, 6
  s_and_b32 s65, s65, 7
  s_lshl_b32 s65, s65, 16
  s_add_u32 s65, s65, s30
  s_waitcnt vmcnt(9)
  buffer_load_dwordx4 v10, s[44:47], s65 offen offset:0 lds
  buffer_load_dwordx4 v11, s[44:47], s65 offen offset:1024 lds
  s_add_u32 m0, s66, 122880
  s_add_u32 s65, s5, 7
  s_and_b32 s65, s65, 7
  s_lshl_b32 s65, s65, 16
  s_add_u32 s65, s65, s30
  s_waitcnt vmcnt(9)
  buffer_load_dwordx4 v10, s[44:47], s65 offen offset:0 lds
  buffer_load_dwordx4 v11, s[44:47], s65 offen offset:1024 lds
  s_waitcnt vmcnt(9)
  v_mfma_f32_32x32x16_bf16 v[32:47], v[132:135], v[140:143], 0
  v_mfma_f32_32x32x16_bf16 v[48:63], v[136:139], v[140:143], 0
  v_mfma_f32_32x32x16_bf16 v[64:79], v[132:135], v[140:143], 0
  v_mfma_f32_32x32x16_bf16 v[80:95], v[136:139], v[140:143], 0
  s_mov_b32 s79, 0
  s_mov_b64 exec, 65535
  s_waitcnt vmcnt(8)
L_poll3:
  v_cmp_ne_u64_e64 vcc, s[68:69], v[20:21]
  s_cbranch_vccz L_pollx4
  buffer_load_dwordx2 v[20:21], v19, s[48:51], s12 offen sc1
  s_add_u32 s79, s79, 1
  s_cmp_lt_u32 s79, 0x40000
  s_waitcnt vmcnt(0)
  s_cbranch_scc1 L_poll3
L_pollx4:
  s_mov_b64 exec, -1
  s_waitcnt lgkmcnt(0)
  s_branch L_p2
L_lf:
  s_cmp_lg_u32 s63, 0
  s_cbranch_scc1 L_gate5
  s_mov_b32 s56, s22
  s_mov_b32 s57, s23
  s_mov_b32 s58, 1024
  s_mov_b32 s59, 0x20000
  s_lshl_b32 s74, s26, 7
  v_add_u32 v29, s74, v1
  v_and_b32 v29, 0x3ff, v29
  s_mov_b32 m0, 155648
  s_nop 0
  buffer_load_dwordx4 v29, s[56:59], 0 offen lds
L_gate5:
  s_load_dword s68, s[28:29], 0
  v_lshl_add_u32 v10, v28, 10, v30
  v_add_u32 v11, 7168, v10
  s_lshl_b32 s64, s72, 2
  s_lshr_b32 s74, s73, 3
  s_add_u32 s64, s64, s74
  s_and_b32 s74, s73, 1
  s_lshl_b32 s74, s74, 1
  s_xor_b32 s64, s64, s74
  s_and_b32 s30, s73, 7
  s_lshl_b32 s30, s30, 7
  s_mul_i32 s4, s72, 21
  s_lshr_b32 s74, s73, 0
  s_and_b32 s74, s74, 7
  s_mul_i32 s5, s74, 0
  s_add_u32 s4, s4, s5
  s_lshr_b32 s4, s4, 3
  s_cmp_ge_u32 s4, 21
  s_cselect_b32 s5, 21, 0
  s_sub_u32 s4, s4, s5
  s_mul_i32 s5, s72, 1
  s_mul_i32 s74, s74, 0
  s_add_u32 s5, s5, s74
  s_mov_b32 s40, s18
  s_mov_b32 s41, s19
  s_mov_b32 s42, 1409024
  s_mov_b32 s43, 0x20000
  s_mov_b32 s44, s10
  s_mov_b32 s45, s11
  s_mov_b32 s46, 524288
  s_mov_b32 s47, 0x20000
  s_mov_b32 s48, s28
  s_mov_b32 s49, s29
  s_mov_b32 s50, 33554432
  s_mov_b32 s51, 0x20000
  v_and_b32 v28, 3, v0
  v_lshlrev_b32_e64 v28, 3, v28
  v_bfe_u32 v29, v0, 4, 1
  v_lshl_add_u32 v28, v29, 5, v28
  v_bfe_u32 v29, v0, 3, 1
  v_lshl_add_u32 v28, v29, 6, v28
  v_bfe_u32 v29, v0, 2, 2
  v_lshl_add_u32 v28, v29, 7, v28
  v_lshrrev_b32_e64 v29, 5, v0
  v_lshl_add_u32 v28, v29, 9, v28
  v_add_u32_e64 v12, s66, v28
  v_add_u32 v13, 0x10000, v12
  v_add_u32 v14, 0x20000, v12
  v_xor_b32_e64 v15, 64, v12
  v_add_u32 v16, 0x10000, v15
  v_add_u32 v17, 0x20000, v15
  v_lshlrev_b32 v19, 7, v0
  v_lshrrev_b32 v22, 5, v0
  v_lshlrev_b32_e64 v22, 28, v22
  v_lshl_add_u32 v22, v0, 1, v22
  s_mul_i32 s74, s64, 245760
  s_lshl_b32 s75, s63, 10
  s_add_u32 s74, s74, s75
  v_add_u32 v18, s74, v1
  v_and_b32 v28, 15, v0
  v_xor_b32 v28, v28, v29
  v_lshlrev_b32 v28, 4, v28
  v_and_b32_e64 v29, 7, v0
  v_lshl_add_u32 v28, v29, 8, v28
  v_bfe_u32 v29, v0, 3, 2
  v_lshl_add_u32 v28, v29, 13, v28
  s_add_u32 s74, s66, 40960
  v_add_u32_e64 v23, s74, v28
  s_add_u32 s27, s26, 1
  s_and_b32 s27, s27, 7
  s_add_u32 m0, s67, 90112
  s_lshl_b32 s65, s27, 7
  s_add_u32 s65, s65, s70
  buffer_load_dwordx4 v2, s[32:35], s65 offen offset:0 lds
  buffer_load_dwordx4 v3, s[32:35], s65 offen offset:1024 lds
  buffer_load_dwordx4 v4, s[32:35], s65 offen offset:2048 lds
  buffer_load_dwordx4 v5, s[32:35], s65 offen offset:3072 lds
  s_add_u32 m0, s66, 131072
  s_mul_i32 s65, s27, 176128
  s_add_u32 s65, s65, s71
  buffer_load_dwordx4 v6, s[36:39], s65 offen offset:0 lds
  buffer_load_dwordx4 v7, s[36:39], s65 offen offset:1024 lds
  s_add_u32 m0, s66, 139264
  s_add_u32 s65, s65, 128
  buffer_load_dwordx4 v6, s[36:39], s65 offen offset:0 lds
  buffer_load_dwordx4 v7, s[36:39], s65 offen offset:1024 lds
  s_add_u32 m0, s66, 147456
  s_add_u32 s65, s65, 128
  buffer_load_dwordx4 v8, s[36:39], s65 offen offset:0 lds
  buffer_load_dwordx4 v9, s[36:39], s65 offen offset:1024 lds
  s_waitcnt vmcnt(10) lgkmcnt(0)
  s_barrier
  s_mul_i32 s68, s68, 1664525
  s_add_u32 s68, s68, 1013904223
  s_xor_b32 s69, s68, 0x9e3779b9
  s_add_u32 s27, s26, 2
  s_and_b32 s27, s27, 7
  s_add_u32 m0, s67, 57344
  s_lshl_b32 s65, s27, 7
  s_add_u32 s65, s65, s70
  buffer_load_dwordx4 v2, s[32:35], s65 offen offset:0 lds
  buffer_load_dwordx4 v3, s[32:35], s65 offen offset:1024 lds
  buffer_load_dwordx4 v4, s[32:35], s65 offen offset:2048 lds
  buffer_load_dwordx4 v5, s[32:35], s65 offen offset:3072 lds
  s_add_u32 m0, s66, 32768
  s_mul_i32 s65, s27, 176128
  s_add_u32 s65, s65, s71
  buffer_load_dwordx4 v6, s[36:39], s65 offen offset:0 lds
  buffer_load_dwordx4 v7, s[36:39], s65 offen offset:1024 lds
  s_add_u32 m0, s66, 40960
  s_add_u32 s65, s65, 128
  buffer_load_dwordx4 v6, s[36:39], s65 offen offset:0 lds
  buffer_load_dwordx4 v7, s[36:39], s65 offen offset:1024 lds
  s_add_u32 m0, s66, 49152
  s_add_u32 s65, s65, 128
  buffer_load_dwordx4 v8, s[36:39], s65 offen offset:0 lds
  buffer_load_dwordx4 v9, s[36:39], s65 offen offset:1024 lds
  s_waitcnt vmcnt(10)
  s_barrier
  s_add_u32 s27, s26, 3
  s_and_b32 s27, s27, 7
  s_add_u32 m0, s67, 73728
  s_lshl_b32 s65, s27, 7
  s_add_u32 s65, s65, s70
  buffer_load_dwordx4 v2, s[32:35], s65 offen offset:0 lds
  buffer_load_dwordx4 v3, s[32:35], s65 offen offset:1024 lds
  buffer_load_dwordx4 v4, s[32:35], s65 offen offset:2048 lds
  buffer_load_dwordx4 v5, s[32:35], s65 offen offset:3072 lds
  s_add_u32 m0, s66, 106496
  s_mul_i32 s65, s27, 176128
  s_add_u32 s65, s65, s71
  buffer_load_dwordx4 v6, s[36:39], s65 offen offset:0 lds
  buffer_load_dwordx4 v7, s[36:39], s65 offen offset:1024 lds
  s_add_u32 m0, s66, 114688
  s_add_u32 s65, s65, 128
  buffer_load_dwordx4 v6, s[36:39], s65 offen offset:0 lds
  buffer_load_dwordx4 v7, s[36:39], s65 offen offset:1024 lds
  s_add_u32 m0, s66, 122880
  s_add_u32 s65, s65, 128
  buffer_load_dwordx4 v8, s[36:39], s65 offen offset:0 lds
  buffer_load_dwordx4 v9, s[36:39], s65 offen offset:1024 lds
  s_waitcnt vmcnt(10)
  s_barrier
  s_add_u32 s27, s26, 4
  s_and_b32 s27, s27, 7
  s_add_u32 m0, s67, 90112
  s_lshl_b32 s65, s27, 7
  s_add_u32 s65, s65, s70
  buffer_load_dwordx4 v2, s[32:35], s65 offen offset:0 lds
  buffer_load_dwordx4 v3, s[32:35], s65 offen offset:1024 lds
  buffer_load_dwordx4 v4, s[32:35], s65 offen offset:2048 lds
  buffer_load_dwordx4 v5, s[32:35], s65 offen offset:3072 lds
  s_add_u32 m0, s66, 131072
  s_mul_i32 s65, s27, 176128
  s_add_u32 s65, s65, s71
  buffer_load_dwordx4 v6, s[36:39], s65 offen offset:0 lds
  buffer_load_dwordx4 v7, s[36:39], s65 offen offset:1024 lds
  s_add_u32 m0, s66, 139264
  s_add_u32 s65, s65, 128
  buffer_load_dwordx4 v6, s[36:39], s65 offen offset:0 lds
  buffer_load_dwordx4 v7, s[36:39], s65 offen offset:1024 lds
  s_add_u32 m0, s66, 147456
  s_add_u32 s65, s65, 128
  buffer_load_dwordx4 v8, s[36:39], s65 offen offset:0 lds
  buffer_load_dwordx4 v9, s[36:39], s65 offen offset:1024 lds
  s_waitcnt vmcnt(10)
  s_barrier
  s_add_u32 s27, s26, 5
  s_and_b32 s27, s27, 7
  s_add_u32 m0, s67, 57344
  s_lshl_b32 s65, s27, 7
  s_add_u32 s65, s65, s70
  buffer_load_dwordx4 v2, s[32:35], s65 offen offset:0 lds
  buffer_load_dwordx4 v3, s[32:35], s65 offen offset:1024 lds
  buffer_load_dwordx4 v4, s[32:35], s65 offen offset:2048 lds
  buffer_load_dwordx4 v5, s[32:35], s65 offen offset:3072 lds
  s_add_u32 m0, s66, 32768
  s_mul_i32 s65, s27, 176128
  s_add_u32 s65, s65, s71
  buffer_load_dwordx4 v6, s[36:39], s65 offen offset:0 lds
  buffer_load_dwordx4 v7, s[36:39], s65 offen offset:1024 lds
  s_add_u32 m0, s66, 40960
  s_add_u32 s65, s65, 128
  buffer_load_dwordx4 v6, s[36:39], s65 offen offset:0 lds
  buffer_load_dwordx4 v7, s[36:39], s65 offen offset:1024 lds
  s_add_u32 m0, s66, 49152
  s_add_u32 s65, s65, 128
  buffer_load_dwordx4 v8, s[36:39], s65 offen offset:0 lds
  buffer_load_dwordx4 v9, s[36:39], s65 offen offset:1024 lds
  s_waitcnt vmcnt(10)
  s_barrier
  s_add_u32 s27, s26, 6
  s_and_b32 s27, s27, 7
  s_add_u32 m0, s67, 73728
  s_lshl_b32 s65, s27, 7
  s_add_u32 s65, s65, s70
  buffer_load_dwordx4 v2, s[32:35], s65 offen offset:0 lds
  buffer_load_dwordx4 v3, s[32:35], s65 offen offset:1024 lds
  buffer_load_dwordx4 v4, s[32:35], s65 offen offset:2048 lds
  buffer_load_dwordx4 v5, s[32:35], s65 offen offset:3072 lds
  s_add_u32 m0, s66, 106496
  s_mul_i32 s65, s27, 176128
  s_add_u32 s65, s65, s71
  buffer_load_dwordx4 v6, s[36:39], s65 offen offset:0 lds
  buffer_load_dwordx4 v7, s[36:39], s65 offen offset:1024 lds
  s_add_u32 m0, s66, 114688
  s_add_u32 s65, s65, 128
  buffer_load_dwordx4 v6, s[36:39], s65 offen offset:0 lds
  buffer_load_dwordx4 v7, s[36:39], s65 offen offset:1024 lds
  s_add_u32 m0, s66, 122880
  s_add_u32 s65, s65, 128
  buffer_load_dwordx4 v8, s[36:39], s65 offen offset:0 lds
  buffer_load_dwordx4 v9, s[36:39], s65 offen offset:1024 lds
  s_waitcnt vmcnt(10)
  s_barrier
  s_add_u32 s27, s26, 7
  s_and_b32 s27, s27, 7
  s_add_u32 m0, s67, 90112
  s_lshl_b32 s65, s27, 7
  s_add_u32 s65, s65, s70
  buffer_load_dwordx4 v2, s[32:35], s65 offen offset:0 lds
  buffer_load_dwordx4 v3, s[32:35], s65 offen offset:1024 lds
  buffer_load_dwordx4 v4, s[32:35], s65 offen offset:2048 lds
  buffer_load_dwordx4 v5, s[32:35], s65 offen offset:3072 lds
  s_add_u32 m0, s66, 131072
  s_mul_i32 s65, s27, 176128
  s_add_u32 s65, s65, s71
  buffer_load_dwordx4 v6, s[36:39], s65 offen offset:0 lds
  buffer_load_dwordx4 v7, s[36:39], s65 offen offset:1024 lds
  s_add_u32 m0, s66, 139264
  s_add_u32 s65, s65, 128
  buffer_load_dwordx4 v6, s[36:39], s65 offen offset:0 lds
  buffer_load_dwordx4 v7, s[36:39], s65 offen offset:1024 lds
  s_add_u32 m0, s66, 147456
  s_add_u32 s65, s65, 128
  buffer_load_dwordx4 v8, s[36:39], s65 offen offset:0 lds
  buffer_load_dwordx4 v9, s[36:39], s65 offen offset:1024 lds
  s_waitcnt vmcnt(10)
  s_barrier
  s_add_u32 m0, s66, 0
  s_cmp_ge_u32 s4, 21
  s_cselect_b32 s65, -21, 0
  s_add_u32 s65, s65, s4
  s_lshl_b32 s65, s65, 16
  s_add_u32 s65, s65, s30
  buffer_load_dwordx4 v10, s[40:43], s65 offen offset:0 lds
  buffer_load_dwordx4 v11, s[40:43], s65 offen offset:1024 lds
  s_add_u32 m0, s66, 8192
  s_cmp_ge_u32 s4, 20
  s_cselect_b32 s65, -20, 1
  s_add_u32 s65, s65, s4
  s_lshl_b32 s65, s65, 16
  s_add_u32 s65, s65, s30
  buffer_load_dwordx4 v10, s[40:43], s65 offen offset:0 lds
  buffer_load_dwordx4 v11, s[40:43], s65 offen offset:1024 lds
  s_add_u32 m0, s66, 16384
  s_cmp_ge_u32 s4, 19
  s_cselect_b32 s65, -19, 2
  s_add_u32 s65, s65, s4
  s_lshl_b32 s65, s65, 16
  s_add_u32 s65, s65, s30
  buffer_load_dwordx4 v10, s[40:43], s65 offen offset:0 lds
  buffer_load_dwordx4 v11, s[40:43], s65 offen offset:1024 lds
  s_add_u32 m0, s66, 24576
  s_cmp_ge_u32 s4, 18
  s_cselect_b32 s65, -18, 3
  s_add_u32 s65, s65, s4
  s_lshl_b32 s65, s65, 16
  s_add_u32 s65, s65, s30
  buffer_load_dwordx4 v10, s[40:43], s65 offen offset:0 lds
  buffer_load_dwordx4 v11, s[40:43], s65 offen offset:1024 lds
  s_waitcnt vmcnt(8)
  s_barrier
  s_add_u32 m0, s66, 32768
  s_cmp_ge_u32 s4, 17
  s_cselect_b32 s65, -17, 4
  s_add_u32 s65, s65, s4
  s_lshl_b32 s65, s65, 16
  s_add_u32 s65, s65, s30
  s_waitcnt vmcnt(6)
  buffer_load_dwordx4 v10, s[40:43], s65 offen offset:0 lds
  buffer_load_dwordx4 v11, s[40:43], s65 offen offset:1024 lds
  ds_read_b64_tr_b16 v[144:145], v12 offset:0
  ds_read_b64_tr_b16 v[146:147], v12 offset:1024
  ds_read_b64_tr_b16 v[148:149], v15 offset:0
  ds_read_b64_tr_b16 v[150:151], v15 offset:1024
  s_add_u32 m0, s66, 40960
  s_cmp_ge_u32 s4, 16
  s_cselect_b32 s65, -16, 5
  s_add_u32 s65, s65, s4
  s_lshl_b32 s65, s65, 16
  s_add_u32 s65, s65, s30
  s_waitcnt vmcnt(6)
  buffer_load_dwordx4 v10, s[40:43], s65 offen offset:0 lds
  buffer_load_dwordx4 v11, s[40:43], s65 offen offset:1024 lds
  ds_read_b64_tr_b16 v[152:153], v12 offset:8192
  ds_read_b64_tr_b16 v[154:155], v12 offset:9216
  ds_read_b64_tr_b16 v[156:157], v15 offset:8192
  ds_read_b64_tr_b16 v[158:159], v15 offset:9216
  s_add_u32 m0, s66, 49152
  s_cmp_ge_u32 s4, 15
  s_cselect_b32 s65, -15, 6
  s_add_u32 s65, s65, s4
  s_lshl_b32 s65, s65, 16
  s_add_u32 s65, s65, s30
  s_waitcnt vmcnt(6)
  buffer_load_dwordx4 v10, s[40:43], s65 offen offset:0 lds
  buffer_load_dwordx4 v11, s[40:43], s65 offen offset:1024 lds
  ds_read_b64_tr_b16 v[160:161], v12 offset:16384
  ds_read_b64_tr_b16 v[162:163], v12 offset:17408
  ds_read_b64_tr_b16 v[164:165], v15 offset:16384
  ds_read_b64_tr_b16 v[166:167], v15 offset:17408
  s_barrier
  s_waitcnt lgkmcnt(8)
  s_add_u32 m0, s66, 0
  s_cmp_ge_u32 s4, 14
  s_cselect_b32 s65, -14, 7
  s_add_u32 s65, s65, s4
  s_lshl_b32 s65, s65, 16
  s_add_u32 s65, s65, s30
  s_waitcnt vmcnt(6)
  buffer_load_dwordx4 v10, s[40:43], s65 offen offset:0 lds
  buffer_load_dwordx4 v11, s[40:43], s65 offen offset:1024 lds
  ds_read_b64_tr_b16 v[168:169], v12 offset:24576
  ds_read_b64_tr_b16 v[170:171], v12 offset:25600
  ds_read_b64_tr_b16 v[172:173], v15 offset:24576
  ds_read_b64_tr_b16 v[174:175], v15 offset:25600
  s_waitcnt lgkmcnt(8)
  s_add_u32 m0, s66, 8192
  s_cmp_ge_u32 s4, 13
  s_cselect_b32 s65, -13, 8
  s_add_u32 s65, s65, s4
  s_lshl_b32 s65, s65, 16
  s_add_u32 s65, s65, s30
  s_waitcnt vmcnt(6)
  buffer_load_dwordx4 v10, s[40:43], s65 offen offset:0 lds
  buffer_load_dwordx4 v11, s[40:43], s65 offen offset:1024 lds
  ds_read_b64_tr_b16 v[176:177], v12 offset:32768
  ds_read_b64_tr_b16 v[178:179], v12 offset:33792
  ds_read_b64_tr_b16 v[180:181], v15 offset:32768
  ds_read_b64_tr_b16 v[182:183], v15 offset:33792
  s_waitcnt lgkmcnt(8)
  s_add_u32 m0, s66, 16384
  s_cmp_ge_u32 s4, 12
  s_cselect_b32 s65, -12, 9
  s_add_u32 s65, s65, s4
  s_lshl_b32 s65, s65, 16
  s_add_u32 s65, s65, s30
  s_waitcnt vmcnt(6)
  buffer_load_dwordx4 v10, s[40:43], s65 offen offset:0 lds
  buffer_load_dwordx4 v11, s[40:43], s65 offen offset:1024 lds
  ds_read_b64_tr_b16 v[184:185], v12 offset:40960
  ds_read_b64_tr_b16 v[186:187], v12 offset:41984
  ds_read_b64_tr_b16 v[188:189], v15 offset:40960
  ds_read_b64_tr_b16 v[190:191], v15 offset:41984
  s_waitcnt vmcnt(6)
  ds_read_b64_tr_b16 v[192:193], v12 offset:49152
  ds_read_b64_tr_b16 v[194:195], v12 offset:50176
  ds_read_b64_tr_b16 v[196:197], v15 offset:49152
  ds_read_b64_tr_b16 v[198:199], v15 offset:50176
  s_waitcnt vmcnt(4)
  ds_read_b64_tr_b16 v[200:201], v12 offset:0
  ds_read_b64_tr_b16 v[202:203], v12 offset:1024
  ds_read_b64_tr_b16 v[204:205], v15 offset:0
  ds_read_b64_tr_b16 v[206:207], v15 offset:1024
  s_waitcnt vmcnt(2)
  ds_read_b64_tr_b16 v[208:209], v12 offset:8192
  ds_read_b64_tr_b16 v[210:211], v12 offset:9216
  ds_read_b64_tr_b16 v[212:213], v15 offset:8192
  ds_read_b64_tr_b16 v[214:215], v15 offset:9216
  s_waitcnt vmcnt(0)
  ds_read_b64_tr_b16 v[216:217], v12 offset:16384
  ds_read_b64_tr_b16 v[218:219], v12 offset:17408
  ds_read_b64_tr_b16 v[220:221], v15 offset:16384
  ds_read_b64_tr_b16 v[222:223], v15 offset:17408
  s_barrier
  s_waitcnt lgkmcnt(15)
  s_add_u32 m0, s66, 24576
  s_cmp_ge_u32 s4, 11
  s_cselect_b32 s65, -11, 10
  s_add_u32 s65, s65, s4
  s_lshl_b32 s65, s65, 16
  s_add_u32 s65, s65, s30
  buffer_load_dwordx4 v10, s[40:43], s65 offen offset:0 lds
  buffer_load_dwordx4 v11, s[40:43], s65 offen offset:1024 lds
  s_add_u32 m0, s66, 32768
  s_cmp_ge_u32 s4, 10
  s_cselect_b32 s65, -10, 11
  s_add_u32 s65, s65, s4
  s_lshl_b32 s65, s65, 16
  s_add_u32 s65, s65, s30
  buffer_load_dwordx4 v10, s[40:43], s65 offen offset:0 lds
  buffer_load_dwordx4 v11, s[40:43], s65 offen offset:1024 lds
  s_add_u32 m0, s66, 40960
  s_cmp_ge_u32 s4, 9
  s_cselect_b32 s65, -9, 12
  s_add_u32 s65, s65, s4
  s_lshl_b32 s65, s65, 16
  s_add_u32 s65, s65, s30
  buffer_load_dwordx4 v10, s[40:43], s65 offen offset:0 lds
  buffer_load_dwordx4 v11, s[40:43], s65 offen offset:1024 lds
  s_waitcnt lgkmcnt(12)
  s_add_u32 m0, s66, 49152
  s_cmp_ge_u32 s4, 8
  s_cselect_b32 s65, -8, 13
  s_add_u32 s65, s65, s4
  s_lshl_b32 s65, s65, 16
  s_add_u32 s65, s65, s30
  buffer_load_dwordx4 v10, s[40:43], s65 offen offset:0 lds
  buffer_load_dwordx4 v11, s[40:43], s65 offen offset:1024 lds
  s_add_u32 m0, s66, 57344
  s_cmp_ge_u32 s4, 7
  s_cselect_b32 s65, -7, 14
  s_add_u32 s65, s65, s4
  s_lshl_b32 s65, s65, 16
  s_add_u32 s65, s65, s30
  s_waitcnt vmcnt(6)
  buffer_load_dwordx4 v10, s[40:43], s65 offen offset:0 lds
  buffer_load_dwordx4 v11, s[40:43], s65 offen offset:1024 lds
  ds_read_b64_tr_b16 v[224:225], v12 offset:24576
  ds_read_b64_tr_b16 v[226:227], v12 offset:25600
  ds_read_b64_tr_b16 v[228:229], v15 offset:24576
  ds_read_b64_tr_b16 v[230:231], v15 offset:25600
  s_add_u32 m0, s66, 65536
  s_cmp_ge_u32 s4, 6
  s_cselect_b32 s65, -6, 15
  s_add_u32 s65, s65, s4
  s_lshl_b32 s65, s65, 16
  s_add_u32 s65, s65, s30
  s_waitcnt vmcnt(6)
  buffer_load_dwordx4 v10, s[40:43], s65 offen offset:0 lds
  buffer_load_dwordx4 v11, s[40:43], s65 offen offset:1024 lds
  ds_read_b64_tr_b16 v[232:233], v12 offset:32768
  ds_read_b64_tr_b16 v[234:235], v12 offset:33792
  ds_read_b64_tr_b16 v[236:237], v15 offset:32768
  ds_read_b64_tr_b16 v[238:239], v15 offset:33792
  s_add_u32 m0, s66, 73728
  s_cmp_ge_u32 s4, 5
  s_cselect_b32 s65, -5, 16
  s_add_u32 s65, s65, s4
  s_lshl_b32 s65, s65, 16
  s_add_u32 s65, s65, s30
  s_waitcnt vmcnt(6)
  buffer_load_dwordx4 v10, s[40:43], s65 offen offset:0 lds
  buffer_load_dwordx4 v11, s[40:43], s65 offen offset:1024 lds
  ds_read_b64_tr_b16 v[240:241], v12 offset:40960
  ds_read_b64_tr_b16 v[242:243], v12 offset:41984
  ds_read_b64_tr_b16 v[244:245], v15 offset:40960
  ds_read_b64_tr_b16 v[246:247], v15 offset:41984
  s_add_u32 m0, s66, 90112
  s_cmp_ge_u32 s4, 2
  s_cselect_b32 s65, -2, 19
  s_add_u32 s65, s65, s4
  s_lshl_b32 s65, s65, 16
  s_add_u32 s65, s65, s30
  s_waitcnt vmcnt(6)
  buffer_load_dwordx4 v10, s[40:43], s65 offen offset:0 lds
  buffer_load_dwordx4 v11, s[40:43], s65 offen offset:1024 lds
  ds_read_b64_tr_b16 v[248:249], v12 offset:49152
  ds_read_b64_tr_b16 v[250:251], v12 offset:50176
  ds_read_b64_tr_b16 v[252:253], v15 offset:49152
  ds_read_b64_tr_b16 v[254:255], v15 offset:50176
  s_add_u32 m0, s66, 98304
  s_cmp_ge_u32 s4, 1
  s_cselect_b32 s65, -1, 20
  s_add_u32 s65, s65, s4
  s_lshl_b32 s65, s65, 16
  s_add_u32 s65, s65, s30
  s_waitcnt vmcnt(6)
  buffer_load_dwordx4 v10, s[40:43], s65 offen offset:0 lds
  buffer_load_dwordx4 v11, s[40:43], s65 offen offset:1024 lds
  s_add_u32 m0, s66, 139264
  s_mov_b32 s65, 1376256
  s_add_u32 s65, s65, s30
  s_waitcnt vmcnt(6)
  buffer_load_dwordx4 v10, s[40:43], s65 offen offset:0 lds
  buffer_load_dwordx4 v11, s[40:43], s65 offen offset:1024 lds
  s_add_u32 m0, s66, 106496
  s_add_u32 s65, s5, 5
  s_and_b32 s65, s65, 7
  s_lshl_b32 s65, s65, 16
  s_add_u32 s65, s65, s30
  s_waitcnt vmcnt(6)
  buffer_load_dwordx4 v10, s[44:47], s65 offen offset:0 lds
  buffer_load_dwordx4 v11, s[44:47], s65 offen offset:1024 lds
  s_add_u32 m0, s66, 114688
  s_add_u32 s65, s5, 6
  s_and_b32 s65, s65, 7
  s_lshl_b32 s65, s65, 16
  s_add_u32 s65, s65, s30
  s_waitcnt vmcnt(6)
  buffer_load_dwordx4 v10, s[44:47], s65 offen offset:0 lds
  buffer_load_dwordx4 v11, s[44:47], s65 offen offset:1024 lds
  s_add_u32 m0, s66, 122880
  s_add_u32 s65, s5, 7
  s_and_b32 s65, s65, 7
  s_lshl_b32 s65, s65, 16
  s_add_u32 s65, s65, s30
  s_waitcnt vmcnt(6)
  buffer_load_dwordx4 v10, s[44:47], s65 offen offset:0 lds
  buffer_load_dwordx4 v11, s[44:47], s65 offen offset:1024 lds
  s_waitcnt lgkmcnt(15)
  s_add_u32 m0, s66, 0
  s_add_u32 s65, s5, 1
  s_and_b32 s65, s65, 7
  s_lshl_b32 s65, s65, 16
  s_add_u32 s65, s65, s30
  s_waitcnt vmcnt(6)
  buffer_load_dwordx4 v10, s[44:47], s65 offen offset:0 lds
  buffer_load_dwordx4 v11, s[44:47], s65 offen offset:1024 lds
  s_add_u32 m0, s66, 8192
  s_add_u32 s65, s5, 2
  s_and_b32 s65, s65, 7
  s_lshl_b32 s65, s65, 16
  s_add_u32 s65, s65, s30
  s_waitcnt vmcnt(6)
  buffer_load_dwordx4 v10, s[44:47], s65 offen offset:0 lds
  buffer_load_dwordx4 v11, s[44:47], s65 offen offset:1024 lds
  s_add_u32 m0, s66, 16384
  s_add_u32 s65, s5, 3
  s_and_b32 s65, s65, 7
  s_lshl_b32 s65, s65, 16
  s_add_u32 s65, s65, s30
  s_waitcnt vmcnt(6)
  buffer_load_dwordx4 v10, s[44:47], s65 offen offset:0 lds
  buffer_load_dwordx4 v11, s[44:47], s65 offen offset:1024 lds
  s_mov_b32 s56, s20
  s_mov_b32 s57, s21
  s_mov_b32 s58, 1024
  s_mov_b32 s59, 0x20000
  s_cmp_lg_u32 s63, 0
  s_cselect_b32 s72, 1879048192, 0
  s_add_u32 s72, s72, s30
  buffer_load_ushort v132, v22, s[56:59], s72 offen offset:0
  v_mov_b32 v133, 0
  v_mov_b32 v134, 0
  v_mov_b32 v135, 0
  buffer_load_ushort v136, v22, s[56:59], s72 offen offset:64
  v_mov_b32 v137, 0
  v_mov_b32 v138, 0
  v_mov_b32_e64 v139, 0
  v_mov_b32 v140, 0x3f803f80
  v_mov_b32 v141, 0x3f803f80
  v_mov_b32 v142, 0x3f803f80
  v_mov_b32 v143, 0x3f803f80
  s_cmp_ge_u32 s63, 2
  s_cselect_b32 s3, 1879048192, 0
  s_add_u32 s3, s3, 86016
  s_lshl_b32 s12, s64, 12
  s_add_u32 s12, s12, 851968
  s_mov_b64 exec, 65535
  buffer_load_dwordx2 v[20:21], v19, s[48:51], s12 offen sc1
  s_mov_b64 exec, -1
  s_waitcnt lgkmcnt(12)
  s_add_u32 m0, s66, 24576
  s_add_u32 s65, s5, 4
  s_and_b32 s65, s65, 7
  s_lshl_b32 s65, s65, 16
  s_add_u32 s65, s65, s30
  s_waitcnt vmcnt(9)
  buffer_load_dwordx4 v10, s[44:47], s65 offen offset:0 lds
  buffer_load_dwordx4 v11, s[44:47], s65 offen offset:1024 lds
  s_waitcnt lgkmcnt(8)
  s_add_u32 m0, s66, 32768
  s_add_u32 s65, s5, 0
  s_and_b32 s65, s65, 7
  s_lshl_b32 s65, s65, 16
  s_add_u32 s65, s65, s30
  s_waitcnt vmcnt(9)
  buffer_load_dwordx4 v10, s[44:47], s65 offen offset:0 lds
  buffer_load_dwordx4 v11, s[44:47], s65 offen offset:1024 lds
  s_waitcnt lgkmcnt(4)
  s_add_u32 m0, s66, 40960
  s_cmp_ge_u32 s4, 3
  s_cselect_b32 s65, -3, 18
  s_add_u32 s65, s65, s4
  s_lshl_b32 s65, s65, 16
  s_add_u32 s65, s65, s30
  s_waitcnt vmcnt(9)
  buffer_load_dwordx4 v10, s[40:43], s65 offen offset:0 lds
  buffer_load_dwordx4 v11, s[40:43], s65 offen offset:1024 lds
  s_waitcnt lgkmcnt(0)
  s_add_u32 m0, s66, 49152
  s_cmp_ge_u32 s4, 4
  s_cselect_b32 s65, -4, 17
  s_add_u32 s65, s65, s4
  s_lshl_b32 s65, s65, 16
  s_add_u32 s65, s65, s30
  s_waitcnt vmcnt(9)
  buffer_load_dwordx4 v10, s[40:43], s65 offen offset:0 lds
  buffer_load_dwordx4 v11, s[40:43], s65 offen offset:1024 lds
  s_waitcnt vmcnt(9)
  v_mfma_f32_32x32x16_bf16 v[32:47], v[132:135], v[140:143], 0
  v_mfma_f32_32x32x16_bf16 v[48:63], v[136:139], v[140:143], 0
  v_mfma_f32_32x32x16_bf16 v[64:79], v[132:135], v[140:143], 0
  v_mfma_f32_32x32x16_bf16 v[80:95], v[136:139], v[140:143], 0
  s_mov_b32 s79, 0
  s_mov_b64 exec, 65535
  s_waitcnt vmcnt(8)
L_poll6:
  v_cmp_ne_u64 vcc, s[68:69], v[20:21]
  s_cbranch_vccz L_pollx7
  buffer_load_dwordx2 v[20:21], v19, s[48:51], s12 offen sc1
  s_add_u32 s79, s79, 1
  s_cmp_lt_u32 s79, 0x40000
  s_waitcnt vmcnt(0)
  s_cbranch_scc1 L_poll6
L_pollx7:
  s_mov_b64 exec, -1
  s_waitcnt lgkmcnt(0)
L_p2:
  s_cmp_ge_u32 s4, 21
  s_cselect_b32 s65, -21, 0
  s_add_u32 s65, s65, s4
  s_lshl_b32 s65, s65, 12
  s_add_u32 s65, s65, 1048576
  buffer_load_dwordx4 v[96:99], v18, s[48:51], s65 offen sc1
  s_add_u32 s65, s65, 122880
  buffer_load_dwordx4 v[100:103], v18, s[48:51], s65 offen sc1
  s_cmp_ge_u32 s4, 20
  s_cselect_b32 s65, -20, 1
  s_add_u32 s65, s65, s4
  s_lshl_b32 s65, s65, 12
  s_add_u32 s65, s65, 1048576
  buffer_load_dwordx4 v[104:107], v18, s[48:51], s65 offen sc1
  s_add_u32 s65, s65, 122880
  buffer_load_dwordx4 v[108:111], v18, s[48:51], s65 offen sc1
  s_cmp_ge_u32 s4, 19
  s_cselect_b32 s65, -19, 2
  s_add_u32 s65, s65, s4
  s_lshl_b32 s65, s65, 12
  s_add_u32 s65, s65, 1048576
  buffer_load_dwordx4 v[112:115], v18, s[48:51], s65 offen sc1
  s_add_u32 s65, s65, 122880
  buffer_load_dwordx4 v[116:119], v18, s[48:51], s65 offen sc1
  s_cmp_ge_u32 s4, 18
  s_cselect_b32 s65, -18, 3
  s_add_u32 s65, s65, s4
  s_lshl_b32 s65, s65, 12
  s_add_u32 s65, s65, 1048576
  buffer_load_dwordx4 v[120:123], v18, s[48:51], s65 offen sc1
  s_add_u32 s65, s65, 122880
  buffer_load_dwordx4 v[124:127], v18, s[48:51], s65 offen sc1
  s_cmp_ge_u32 s4, 17
  s_cselect_b32 s65, -17, 4
  s_add_u32 s65, s65, s4
  s_lshl_b32 s65, s65, 12
  s_add_u32 s65, s65, 1048576
  buffer_load_dwordx4 v[128:131], v18, s[48:51], s65 offen sc1
  s_add_u32 s65, s65, 122880
  buffer_load_dwordx4 v[132:135], v18, s[48:51], s65 offen sc1
  s_lshl_b32 s72, s64, 8
  s_add_u32 s72, s72, 131072
  v_and_b32 v28, 31, v0
  v_lshlrev_b32_e64 v28, 2, v28
  buffer_load_dword v24, v28, s[48:51], s72 offen offset:0 sc1
  buffer_load_dword v25, v28, s[48:51], s72 offen offset:128 sc1
  s_lshl_b32 s13, s2, 3
  s_add_u32 s13, s13, s60
  s_waitcnt vmcnt(11)
  v_mfma_f32_32x32x16_bf16 v[32:47], v[144:147], v[96:99], v[32:47]
  s_cmp_ge_u32 s4, 16
  s_cselect_b32 s65, -16, 5
  s_add_u32 s65, s65, s4
  s_lshl_b32 s65, s65, 12
  s_add_u32 s65, s65, 1048576
  buffer_load_dwordx4 v[136:139], v18, s[48:51], s65 offen sc1
  v_mfma_f32_32x32x16_bf16 v[48:63], v[148:151], v[96:99], v[48:63]
  s_waitcnt vmcnt(11)
  v_mfma_f32_32x32x16_bf16 v[64:79], v[144:147], v[100:103], v[64:79]
  s_add_u32 s65, s65, 122880
  buffer_load_dwordx4 v[140:143], v18, s[48:51], s65 offen sc1
  v_mfma_f32_32x32x16_bf16 v[80:95], v[148:151], v[100:103], v[80:95]
  s_waitcnt vmcnt(11)
  v_mfma_f32_32x32x16_bf16 v[32:47], v[152:155], v[104:107], v[32:47]
  s_cmp_ge_u32 s4, 15
  s_cselect_b32 s65, -15, 6
  s_add_u32 s65, s65, s4
  s_lshl_b32 s65, s65, 12
  s_add_u32 s65, s65, 1048576
  buffer_load_dwordx4 v[96:99], v18, s[48:51], s65 offen sc1
  v_mfma_f32_32x32x16_bf16 v[48:63], v[156:159], v[104:107], v[48:63]
  s_waitcnt vmcnt(11)
  v_mfma_f32_32x32x16_bf16 v[64:79], v[152:155], v[108:111], v[64:79]
  s_add_u32 s65, s65, 122880
  buffer_load_dwordx4 v[100:103], v18, s[48:51], s65 offen sc1
  v_mfma_f32_32x32x16_bf16 v[80:95], v[156:159], v[108:111], v[80:95]
  s_waitcnt vmcnt(11)
  v_mfma_f32_32x32x16_bf16 v[32:47], v[160:163], v[112:115], v[32:47]
  s_cmp_ge_u32 s4, 14
  s_cselect_b32 s65, -14, 7
  s_add_u32 s65, s65, s4
  s_lshl_b32 s65, s65, 12
  s_add_u32 s65, s65, 1048576
  buffer_load_dwordx4 v[104:107], v18, s[48:51], s65 offen sc1
  v_mfma_f32_32x32x16_bf16 v[48:63], v[164:167], v[112:115], v[48:63]
  s_waitcnt vmcnt(11)
  v_mfma_f32_32x32x16_bf16 v[64:79], v[160:163], v[116:119], v[64:79]
  s_add_u32 s65, s65, 122880
  buffer_load_dwordx4 v[108:111], v18, s[48:51], s65 offen sc1
  v_mfma_f32_32x32x16_bf16 v[80:95], v[164:167], v[116:119], v[80:95]
  s_waitcnt vmcnt(11)
  v_mfma_f32_32x32x16_bf16 v[32:47], v[168:171], v[120:123], v[32:47]
  s_cmp_ge_u32 s4, 13
  s_cselect_b32 s65, -13, 8
  s_add_u32 s65, s65, s4
  s_lshl_b32 s65, s65, 12
  s_add_u32 s65, s65, 1048576
  buffer_load_dwordx4 v[112:115], v18, s[48:51], s65 offen sc1
  v_mfma_f32_32x32x16_bf16 v[48:63], v[172:175], v[120:123], v[48:63]
  s_waitcnt vmcnt(11)
  v_mfma_f32_32x32x16_bf16 v[64:79], v[168:171], v[124:127], v[64:79]
  s_add_u32 s65, s65, 122880
  buffer_load_dwordx4 v[116:119], v18, s[48:51], s65 offen sc1
  v_mfma_f32_32x32x16_bf16 v[80:95], v[172:175], v[124:127], v[80:95]
  s_waitcnt vmcnt(11)
  v_mfma_f32_32x32x16_bf16 v[32:47], v[176:179], v[128:131], v[32:47]
  s_cmp_ge_u32 s4, 12
  s_cselect_b32 s65, -12, 9
  s_add_u32 s65, s65, s4
  s_lshl_b32 s65, s65, 12
  s_add_u32 s65, s65, 1048576
  buffer_load_dwordx4 v[120:123], v18, s[48:51], s65 offen sc1
  v_mfma_f32_32x32x16_bf16 v[48:63], v[180:183], v[128:131], v[48:63]
  s_waitcnt vmcnt(11)
  v_mfma_f32_32x32x16_bf16 v[64:79], v[176:179], v[132:135], v[64:79]
  s_add_u32 s65, s65, 122880
  buffer_load_dwordx4 v[124:127], v18, s[48:51], s65 offen sc1
  v_mfma_f32_32x32x16_bf16 v[80:95], v[180:183], v[132:135], v[80:95]
  s_waitcnt vmcnt(9)
  v_mfma_f32_32x32x16_bf16 v[32:47], v[184:187], v[136:139], v[32:47]
  s_cmp_ge_u32 s4, 11
  s_cselect_b32 s65, -11, 10
  s_add_u32 s65, s65, s4
  s_lshl_b32 s65, s65, 12
  s_add_u32 s65, s65, 1048576
  buffer_load_dwordx4 v[128:131], v18, s[48:51], s65 offen sc1
  v_mfma_f32_32x32x16_bf16 v[48:63], v[188:191], v[136:139], v[48:63]
  s_waitcnt vmcnt(9)
  v_mfma_f32_32x32x16_bf16 v[64:79], v[184:187], v[140:143], v[64:79]
  s_add_u32 s65, s65, 122880
  buffer_load_dwordx4 v[132:135], v18, s[48:51], s65 offen sc1
  v_mfma_f32_32x32x16_bf16 v[80:95], v[188:191], v[140:143], v[80:95]
  s_waitcnt vmcnt(9)
  v_mfma_f32_32x32x16_bf16 v[32:47], v[192:195], v[96:99], v[32:47]
  s_cmp_ge_u32 s4, 10
  s_cselect_b32 s65, -10, 11
  s_add_u32 s65, s65, s4
  s_lshl_b32 s65, s65, 12
  s_add_u32 s65, s65, 1048576
  buffer_load_dwordx4 v[136:139], v18, s[48:51], s65 offen sc1
  v_mfma_f32_32x32x16_bf16 v[48:63], v[196:199], v[96:99], v[48:63]
  s_waitcnt vmcnt(9)
  v_mfma_f32_32x32x16_bf16 v[64:79], v[192:195], v[100:103], v[64:79]
  s_add_u32 s65, s65, 122880
  buffer_load_dwordx4 v[140:143], v18, s[48:51], s65 offen sc1
  v_mfma_f32_32x32x16_bf16 v[80:95], v[196:199], v[100:103], v[80:95]
  s_waitcnt vmcnt(9)
  v_mfma_f32_32x32x16_bf16 v[32:47], v[200:203], v[104:107], v[32:47]
  s_cmp_ge_u32 s4, 9
  s_cselect_b32 s65, -9, 12
  s_add_u32 s65, s65, s4
  s_lshl_b32 s65, s65, 12
  s_add_u32 s65, s65, 1048576
  buffer_load_dwordx4 v[96:99], v18, s[48:51], s65 offen sc1
  v_mfma_f32_32x32x16_bf16 v[48:63], v[204:207], v[104:107], v[48:63]
  s_waitcnt vmcnt(9)
  v_mfma_f32_32x32x16_bf16 v[64:79], v[200:203], v[108:111], v[64:79]
  s_add_u32 s65, s65, 122880
  buffer_load_dwordx4 v[100:103], v18, s[48:51], s65 offen sc1
  v_mfma_f32_32x32x16_bf16 v[80:95], v[204:207], v[108:111], v[80:95]
  s_waitcnt vmcnt(9)
  v_mfma_f32_32x32x16_bf16 v[32:47], v[208:211], v[112:115], v[32:47]
  s_cmp_ge_u32 s4, 8
  s_cselect_b32 s65, -8, 13
  s_add_u32 s65, s65, s4
  s_lshl_b32 s65, s65, 12
  s_add_u32 s65, s65, 1048576
  buffer_load_dwordx4 v[104:107], v18, s[48:51], s65 offen sc1
  v_mfma_f32_32x32x16_bf16 v[48:63], v[212:215], v[112:115], v[48:63]
  s_waitcnt vmcnt(9)
  v_mfma_f32_32x32x16_bf16 v[64:79], v[208:211], v[116:119], v[64:79]
  s_add_u32 s65, s65, 122880
  buffer_load_dwordx4 v[108:111], v18, s[48:51], s65 offen sc1
  v_mfma_f32_32x32x16_bf16 v[80:95], v[212:215], v[116:119], v[80:95]
  s_waitcnt vmcnt(9)
  v_mfma_f32_32x32x16_bf16 v[32:47], v[216:219], v[120:123], v[32:47]
  s_cmp_ge_u32 s4, 7
  s_cselect_b32 s65, -7, 14
  s_add_u32 s65, s65, s4
  s_lshl_b32 s65, s65, 12
  s_add_u32 s65, s65, 1048576
  buffer_load_dwordx4 v[112:115], v18, s[48:51], s65 offen sc1
  v_mfma_f32_32x32x16_bf16 v[48:63], v[220:223], v[120:123], v[48:63]
  s_waitcnt vmcnt(9)
  v_mfma_f32_32x32x16_bf16 v[64:79], v[216:219], v[124:127], v[64:79]
  s_add_u32 s65, s65, 122880
  buffer_load_dwordx4 v[116:119], v18, s[48:51], s65 offen sc1
  v_mfma_f32_32x32x16_bf16 v[80:95], v[220:223], v[124:127], v[80:95]
  s_waitcnt vmcnt(9)
  v_mfma_f32_32x32x16_bf16 v[32:47], v[224:227], v[128:131], v[32:47]
  s_cmp_ge_u32 s4, 6
  s_cselect_b32 s65, -6, 15
  s_add_u32 s65, s65, s4
  s_lshl_b32 s65, s65, 12
  s_add_u32 s65, s65, 1048576
  buffer_load_dwordx4 v[120:123], v18, s[48:51], s65 offen sc1
  v_mfma_f32_32x32x16_bf16 v[48:63], v[228:231], v[128:131], v[48:63]
  s_waitcnt vmcnt(9)
  v_mfma_f32_32x32x16_bf16 v[64:79], v[224:227], v[132:135], v[64:79]
  s_add_u32 s65, s65, 122880
  buffer_load_dwordx4 v[124:127], v18, s[48:51], s65 offen sc1
  v_mfma_f32_32x32x16_bf16 v[80:95], v[228:231], v[132:135], v[80:95]
  s_waitcnt vmcnt(9)
  v_mfma_f32_32x32x16_bf16 v[32:47], v[232:235], v[136:139], v[32:47]
  s_cmp_ge_u32 s4, 5
  s_cselect_b32 s65, -5, 16
  s_add_u32 s65, s65, s4
  s_lshl_b32 s65, s65, 12
  s_add_u32 s65, s65, 1048576
  buffer_load_dwordx4 v[128:131], v18, s[48:51], s65 offen sc1
  v_mfma_f32_32x32x16_bf16 v[48:63], v[236:239], v[136:139], v[48:63]
  s_waitcnt vmcnt(9)
  v_mfma_f32_32x32x16_bf16 v[64:79], v[232:235], v[140:143], v[64:79]
  s_add_u32 s65, s65, 122880
  buffer_load_dwordx4 v[132:135], v18, s[48:51], s65 offen sc1
  v_mfma_f32_32x32x16_bf16 v[80:95], v[236:239], v[140:143], v[80:95]
  s_waitcnt vmcnt(9)
  v_mfma_f32_32x32x16_bf16 v[32:47], v[240:243], v[96:99], v[32:47]
  s_cmp_ge_u32 s4, 4
  s_cselect_b32 s65, -4, 17
  s_add_u32 s65, s65, s4
  s_lshl_b32 s65, s65, 12
  s_add_u32 s65, s65, 1048576
  buffer_load_dwordx4 v[136:139], v18, s[48:51], s65 offen sc1
  v_mfma_f32_32x32x16_bf16 v[48:63], v[244:247], v[96:99], v[48:63]
  ds_read_b64_tr_b16 v[144:145], v12 offset:57344
  ds_read_b64_tr_b16 v[146:147], v12 offset:58368
  ds_read_b64_tr_b16 v[148:149], v15 offset:57344
  ds_read_b64_tr_b16 v[150:151], v15 offset:58368
  s_waitcnt vmcnt(9)
  v_mfma_f32_32x32x16_bf16 v[64:79], v[240:243], v[100:103], v[64:79]
  s_add_u32 s65, s65, 122880
  buffer_load_dwordx4 v[140:143], v18, s[48:51], s65 offen sc1
  v_mfma_f32_32x32x16_bf16 v[80:95], v[244:247], v[100:103], v[80:95]
  s_waitcnt vmcnt(9)
  v_mfma_f32_32x32x16_bf16 v[32:47], v[248:251], v[104:107], v[32:47]
  s_cmp_lg_u32 s13, 2047
  s_cbranch_scc1 L_ep8
  v_lshrrev_b32 v28, 3, v0
  v_and_b32 v29, 7, v0
  v_lshlrev_b32_e64 v29, 8, v29
  v_lshl_add_u32 v19, v28, 13, v29
  s_mov_b32 s12, 851968
  s_mov_b64 exec, -1
  buffer_load_dwordx2 v[20:21], v19, s[48:51], s12 offen sc1
  s_mov_b64 exec, -1
  s_mov_b32 s79, 0
  s_mov_b64 exec, -1
  s_waitcnt vmcnt(0)
L_poll9:
  v_cmp_ne_u64_e64 vcc, s[68:69], v[20:21]
  s_cbranch_vccz L_pollx10
  buffer_load_dwordx2 v[20:21], v19, s[48:51], s12 offen sc1
  s_add_u32 s79, s79, 1
  s_cmp_lt_u32 s79, 0x40000
  s_waitcnt vmcnt(0)
  s_cbranch_scc1 L_poll9
L_pollx10:
  s_mov_b64 exec, -1
  s_mov_b32 s12, 917504
  s_mov_b64 exec, -1
  buffer_load_dwordx2 v[20:21], v19, s[48:51], s12 offen sc1
  s_mov_b64 exec, -1
  s_mov_b32 s79, 0
  s_mov_b64 exec, -1
  s_waitcnt vmcnt(0)
L_poll11:
  v_cmp_ne_u64_e64 vcc, s[68:69], v[20:21]
  s_cbranch_vccz L_pollx12
  buffer_load_dwordx2 v[20:21], v19, s[48:51], s12 offen sc1
  s_add_u32 s79, s79, 1
  s_cmp_lt_u32 s79, 0x40000
  s_waitcnt vmcnt(0)
  s_cbranch_scc1 L_poll11
L_pollx12:
  s_mov_b64 exec, -1
  v_lshlrev_b32 v19, 7, v0
L_ep8:
  s_lshl_b32 s12, s64, 12
  s_add_u32 s12, s12, 854016
  s_mov_b64 exec, 65535
  buffer_load_dwordx2 v[20:21], v19, s[48:51], s12 offen sc1
  s_mov_b64 exec, -1
  s_cmp_ge_u32 s4, 3
  s_cselect_b32 s65, -3, 18
  s_add_u32 s65, s65, s4
  s_lshl_b32 s65, s65, 12
  s_add_u32 s65, s65, 1048576
  buffer_load_dwordx4 v[96:99], v18, s[48:51], s65 offen sc1
  v_mfma_f32_32x32x16_bf16 v[48:63], v[252:255], v[104:107], v[48:63]
  ds_read_b64_tr_b16 v[152:153], v13 offset:0
  ds_read_b64_tr_b16 v[154:155], v13 offset:1024
  ds_read_b64_tr_b16 v[156:157], v16 offset:0
  ds_read_b64_tr_b16 v[158:159], v16 offset:1024
  s_waitcnt vmcnt(10)
  v_mfma_f32_32x32x16_bf16 v[64:79], v[248:251], v[108:111], v[64:79]
  s_add_u32 s65, s65, 122880
  buffer_load_dwordx4 v[100:103], v18, s[48:51], s65 offen sc1
  v_mfma_f32_32x32x16_bf16 v[80:95], v[252:255], v[108:111], v[80:95]
  s_waitcnt vmcnt(10) lgkmcnt(4)
  v_mfma_f32_32x32x16_bf16 v[32:47], v[144:147], v[112:115], v[32:47]
  s_cmp_ge_u32 s4, 2
  s_cselect_b32 s65, -2, 19
  s_add_u32 s65, s65, s4
  s_lshl_b32 s65, s65, 12
  s_add_u32 s65, s65, 1048576
  buffer_load_dwordx4 v[104:107], v18, s[48:51], s65 offen sc1
  v_mfma_f32_32x32x16_bf16 v[48:63], v[148:151], v[112:115], v[48:63]
  ds_read_b64_tr_b16 v[160:161], v13 offset:8192
  ds_read_b64_tr_b16 v[162:163], v13 offset:9216
  ds_read_b64_tr_b16 v[164:165], v16 offset:8192
  ds_read_b64_tr_b16 v[166:167], v16 offset:9216
  s_waitcnt vmcnt(10)
  v_mfma_f32_32x32x16_bf16 v[64:79], v[144:147], v[116:119], v[64:79]
  s_add_u32 s65, s65, 122880
  buffer_load_dwordx4 v[108:111], v18, s[48:51], s65 offen sc1
  v_mfma_f32_32x32x16_bf16 v[80:95], v[148:151], v[116:119], v[80:95]
  s_waitcnt vmcnt(10) lgkmcnt(4)
  v_mfma_f32_32x32x16_bf16 v[32:47], v[152:155], v[120:123], v[32:47]
  s_cmp_ge_u32 s4, 1
  s_cselect_b32 s65, -1, 20
  s_add_u32 s65, s65, s4
  s_lshl_b32 s65, s65, 12
  s_add_u32 s65, s65, 1048576
  buffer_load_dwordx4 v[112:115], v18, s[48:51], s65 offen sc1
  v_mfma_f32_32x32x16_bf16 v[48:63], v[156:159], v[120:123], v[48:63]
  ds_read_b64_tr_b16 v[144:145], v12 offset:49152
  ds_read_b64_tr_b16 v[146:147], v12 offset:50176
  ds_read_b64_tr_b16 v[148:149], v15 offset:49152
  ds_read_b64_tr_b16 v[150:151], v15 offset:50176
  s_waitcnt vmcnt(10)
  v_mfma_f32_32x32x16_bf16 v[64:79], v[152:155], v[124:127], v[64:79]
  s_add_u32 s65, s65, 122880
  buffer_load_dwordx4 v[116:119], v18, s[48:51], s65 offen sc1
  v_mfma_f32_32x32x16_bf16 v[80:95], v[156:159], v[124:127], v[80:95]
  s_waitcnt vmcnt(10) lgkmcnt(4)
  v_mfma_f32_32x32x16_bf16 v[32:47], v[160:163], v[128:131], v[32:47]
  s_add_u32 s65, s3, 1048576
  buffer_load_dwordx4 v[120:123], v18, s[48:51], s65 offen sc1
  v_mfma_f32_32x32x16_bf16 v[48:63], v[164:167], v[128:131], v[48:63]
  ds_read_b64_tr_b16 v[152:153], v12 offset:40960
  ds_read_b64_tr_b16 v[154:155], v12 offset:41984
  ds_read_b64_tr_b16 v[156:157], v15 offset:40960
  ds_read_b64_tr_b16 v[158:159], v15 offset:41984
  s_waitcnt vmcnt(10)
  v_mfma_f32_32x32x16_bf16 v[64:79], v[160:163], v[132:135], v[64:79]
  s_add_u32 s65, s3, 1171456
  buffer_load_dwordx4 v[124:127], v18, s[48:51], s65 offen sc1
  v_mfma_f32_32x32x16_bf16 v[80:95], v[164:167], v[132:135], v[80:95]
  s_waitcnt vmcnt(10) lgkmcnt(4)
  v_mfma_f32_32x32x16_bf16 v[32:47], v[144:147], v[136:139], v[32:47]
  s_mov_b32 s79, 0
  s_mov_b64 exec, 65535
  s_waitcnt vmcnt(8)
L_poll13:
  v_cmp_ne_u64_e64 vcc, s[68:69], v[20:21]
  s_cbranch_vccz L_pollx14
  buffer_load_dwordx2 v[20:21], v19, s[48:51], s12 offen sc1
  s_add_u32 s79, s79, 1
  s_cmp_lt_u32 s79, 0x40000
  s_waitcnt vmcnt(0)
  s_cbranch_scc1 L_poll13
L_pollx14:
  s_mov_b64 exec, -1
  s_cmp_lg_u32 s13, 2047
  s_cbranch_scc1 L_ep15
  v_mov_b32_e64 v20, s68
  s_mov_b64 exec, 1
  buffer_store_dword v20, v1, s[48:51], 0 offen sc1
  s_mov_b64 exec, -1
L_ep15:
  s_add_u32 s65, s5, 0
  s_and_b32 s65, s65, 7
  s_lshl_b32 s65, s65, 12
  s_add_u32 s65, s65, 1138688
  buffer_load_dwordx4 v[128:131], v18, s[48:51], s65 offen sc1
  v_mfma_f32_32x32x16_bf16 v[48:63], v[148:151], v[136:139], v[48:63]
  ds_read_b64_tr_b16 v[160:161], v13 offset:24576
  ds_read_b64_tr_b16 v[162:163], v13 offset:25600
  ds_read_b64_tr_b16 v[164:165], v16 offset:24576
  ds_read_b64_tr_b16 v[166:167], v16 offset:25600
  v_mfma_f32_32x32x16_bf16 v[64:79], v[144:147], v[140:143], v[64:79]
  s_add_u32 s65, s5, 1
  s_and_b32 s65, s65, 7
  s_lshl_b32 s65, s65, 12
  s_add_u32 s65, s65, 1138688
  buffer_load_dwordx4 v[132:135], v18, s[48:51], s65 offen sc1
  v_mfma_f32_32x32x16_bf16 v[80:95], v[148:151], v[140:143], v[80:95]
  s_waitcnt vmcnt(9) lgkmcnt(4)
  v_mfma_f32_32x32x16_bf16 v[32:47], v[152:155], v[96:99], v[32:47]
  s_add_u32 s65, s5, 2
  s_and_b32 s65, s65, 7
  s_lshl_b32 s65, s65, 12
  s_add_u32 s65, s65, 1138688
  buffer_load_dwordx4 v[136:139], v18, s[48:51], s65 offen sc1
  v_mfma_f32_32x32x16_bf16 v[48:63], v[156:159], v[96:99], v[48:63]
  ds_read_b64_tr_b16 v[144:145], v13 offset:32768
  ds_read_b64_tr_b16 v[146:147], v13 offset:33792
  ds_read_b64_tr_b16 v[148:149], v16 offset:32768
  ds_read_b64_tr_b16 v[150:151], v16 offset:33792
  s_waitcnt vmcnt(9)
  v_mfma_f32_32x32x16_bf16 v[64:79], v[152:155], v[100:103], v[64:79]
  s_add_u32 s65, s5, 3
  s_and_b32 s65, s65, 7
  s_lshl_b32 s65, s65, 12
  s_add_u32 s65, s65, 1138688
  buffer_load_dwordx4 v[140:143], v18, s[48:51], s65 offen sc1
  v_mfma_f32_32x32x16_bf16 v[80:95], v[156:159], v[100:103], v[80:95]
  s_waitcnt vmcnt(9) lgkmcnt(4)
  v_mfma_f32_32x32x16_bf16 v[32:47], v[160:163], v[104:107], v[32:47]
  s_add_u32 s65, s5, 4
  s_and_b32 s65, s65, 7
  s_lshl_b32 s65, s65, 12
  s_add_u32 s65, s65, 1138688
  buffer_load_dwordx4 v[96:99], v18, s[48:51], s65 offen sc1
  v_mfma_f32_32x32x16_bf16 v[48:63], v[164:167], v[104:107], v[48:63]
  ds_read_b64_tr_b16 v[152:153], v14 offset:8192
  ds_read_b64_tr_b16 v[154:155], v14 offset:9216
  ds_read_b64_tr_b16 v[156:157], v17 offset:8192
  ds_read_b64_tr_b16 v[158:159], v17 offset:9216
  s_waitcnt vmcnt(9)
  v_mfma_f32_32x32x16_bf16 v[64:79], v[160:163], v[108:111], v[64:79]
  s_add_u32 s65, s5, 5
  s_and_b32 s65, s65, 7
  s_lshl_b32 s65, s65, 12
  s_add_u32 s65, s65, 1138688
  buffer_load_dwordx4 v[100:103], v18, s[48:51], s65 offen sc1
  v_mfma_f32_32x32x16_bf16 v[80:95], v[164:167], v[108:111], v[80:95]
  s_waitcnt vmcnt(9) lgkmcnt(4)
  v_mfma_f32_32x32x16_bf16 v[32:47], v[144:147], v[112:115], v[32:47]
  s_add_u32 s65, s5, 6
  s_and_b32 s65, s65, 7
  s_lshl_b32 s65, s65, 12
  s_add_u32 s65, s65, 1138688
  buffer_load_dwordx4 v[104:107], v18, s[48:51], s65 offen sc1
  v_mfma_f32_32x32x16_bf16 v[48:63], v[148:151], v[112:115], v[48:63]
  ds_read_b64_tr_b16 v[160:161], v12 offset:32768
  ds_read_b64_tr_b16 v[162:163], v12 offset:33792
  ds_read_b64_tr_b16 v[164:165], v15 offset:32768
  ds_read_b64_tr_b16 v[166:167], v15 offset:33792
  s_waitcnt vmcnt(9)
  v_mfma_f32_32x32x16_bf16 v[64:79], v[144:147], v[116:119], v[64:79]
  s_add_u32 s65, s5, 7
  s_and_b32 s65, s65, 7
  s_lshl_b32 s65, s65, 12
  s_add_u32 s65, s65, 1138688
  buffer_load_dwordx4 v[108:111], v18, s[48:51], s65 offen sc1
  v_mfma_f32_32x32x16_bf16 v[80:95], v[148:151], v[116:119], v[80:95]
  s_waitcnt vmcnt(9) lgkmcnt(4)
  v_mfma_f32_32x32x16_bf16 v[32:47], v[152:155], v[120:123], v[32:47]
  s_add_u32 s65, s5, 0
  s_and_b32 s65, s65, 7
  s_lshl_b32 s65, s65, 12
  s_add_u32 s65, s65, 1261568
  buffer_load_dwordx4 v[112:115], v18, s[48:51], s65 offen sc1
  v_mfma_f32_32x32x16_bf16 v[48:63], v[156:159], v[120:123], v[48:63]
  ds_read_b64_tr_b16 v[144:145], v12 offset:0
  ds_read_b64_tr_b16 v[146:147], v12 offset:1024
  ds_read_b64_tr_b16 v[148:149], v15 offset:0
  ds_read_b64_tr_b16 v[150:151], v15 offset:1024
  s_waitcnt vmcnt(9)
  v_mfma_f32_32x32x16_bf16 v[64:79], v[152:155], v[124:127], v[64:79]
  s_add_u32 s65, s5, 1
  s_and_b32 s65, s65, 7
  s_lshl_b32 s65, s65, 12
  s_add_u32 s65, s65, 1261568
  buffer_load_dwordx4 v[116:119], v18, s[48:51], s65 offen sc1
  v_mfma_f32_32x32x16_bf16 v[80:95], v[156:159], v[124:127], v[80:95]
  s_waitcnt vmcnt(9) lgkmcnt(4)
  v_mfma_f32_32x32x16_bf16 v[176:191], v[160:163], v[128:131], 0
  s_add_u32 s65, s5, 2
  s_and_b32 s65, s65, 7
  s_lshl_b32 s65, s65, 12
  s_add_u32 s65, s65, 1261568
  buffer_load_dwordx4 v[120:123], v18, s[48:51], s65 offen sc1
  v_mfma_f32_32x32x16_bf16 v[192:207], v[164:167], v[128:131], 0
  ds_read_b64_tr_b16 v[152:153], v12 offset:8192
  ds_read_b64_tr_b16 v[154:155], v12 offset:9216
  ds_read_b64_tr_b16 v[156:157], v15 offset:8192
  ds_read_b64_tr_b16 v[158:159], v15 offset:9216
  s_waitcnt vmcnt(9) lgkmcnt(4)
  v_mfma_f32_32x32x16_bf16 v[176:191], v[144:147], v[132:135], v[176:191]
  s_add_u32 s65, s5, 3
  s_and_b32 s65, s65, 7
  s_lshl_b32 s65, s65, 12
  s_add_u32 s65, s65, 1261568
  buffer_load_dwordx4 v[124:127], v18, s[48:51], s65 offen sc1
  v_sub_f32 v26, 1.0, v24
  v_mul_f32 v32, v26, v32
  v_mul_f32 v33, v26, v33
  v_mfma_f32_32x32x16_bf16 v[192:207], v[148:151], v[132:135], v[192:207]
  ds_read_b64_tr_b16 v[160:161], v12 offset:16384
  ds_read_b64_tr_b16 v[162:163], v12 offset:17408
  ds_read_b64_tr_b16 v[164:165], v15 offset:16384
  ds_read_b64_tr_b16 v[166:167], v15 offset:17408
  v_mul_f32 v34, v26, v34
  v_mul_f32 v35, v26, v35
  v_mul_f32 v36, v26, v36
  v_mul_f32_e64 v37, v26, v37
  s_waitcnt vmcnt(9) lgkmcnt(4)
  v_mfma_f32_32x32x16_bf16 v[176:191], v[152:155], v[136:139], v[176:191]
  s_add_u32 s65, s5, 4
  s_and_b32 s65, s65, 7
  s_lshl_b32 s65, s65, 12
  s_add_u32 s65, s65, 1261568
  buffer_load_dwordx4 v[128:131], v18, s[48:51], s65 offen sc1
  v_mul_f32 v38, v26, v38
  v_mul_f32 v39, v26, v39
  v_mul_f32 v40, v26, v40
  v_mul_f32_e64 v41, v26, v41
  v_mfma_f32_32x32x16_bf16 v[192:207], v[156:159], v[136:139], v[192:207]
  ds_read_b64_tr_b16 v[144:145], v12 offset:24576
  ds_read_b64_tr_b16 v[146:147], v12 offset:25600
  ds_read_b64_tr_b16 v[148:149], v15 offset:24576
  ds_read_b64_tr_b16 v[150:151], v15 offset:25600
  v_mul_f32 v42, v26, v42
  v_mul_f32 v43, v26, v43
  v_mul_f32 v44, v26, v44
  v_mul_f32 v45, v26, v45
  v_mul_f32 v46, v26, v46
  s_waitcnt vmcnt(9) lgkmcnt(4)
  v_mfma_f32_32x32x16_bf16 v[176:191], v[160:163], v[140:143], v[176:191]
  s_add_u32 s65, s5, 5
  s_and_b32 s65, s65, 7
  s_lshl_b32 s65, s65, 12
  s_add_u32 s65, s65, 1261568
  buffer_load_dwordx4 v[132:135], v18, s[48:51], s65 offen sc1
  v_mul_f32 v47, v26, v47
  v_mul_f32 v48, v26, v48
  v_mul_f32 v49, v26, v49
  v_mul_f32_e64 v50, v26, v50
  v_mfma_f32_32x32x16_bf16 v[192:207], v[164:167], v[140:143], v[192:207]
  ds_read_b64_tr_b16 v[152:153], v13 offset:40960
  ds_read_b64_tr_b16 v[154:155], v13 offset:41984
  ds_read_b64_tr_b16 v[156:157], v16 offset:40960
  ds_read_b64_tr_b16 v[158:159], v16 offset:41984
  v_mul_f32 v51, v26, v51
  v_mul_f32 v52, v26, v52
  v_mul_f32 v53, v26, v53
  v_mul_f32_e64 v54, v26, v54
  s_waitcnt vmcnt(9) lgkmcnt(4)
  v_mfma_f32_32x32x16_bf16 v[176:191], v[144:147], v[96:99], v[176:191]
  s_add_u32 s65, s5, 6
  s_and_b32 s65, s65, 7
  s_lshl_b32 s65, s65, 12
  s_add_u32 s65, s65, 1261568
  buffer_load_dwordx4 v[136:139], v18, s[48:51], s65 offen sc1
  v_mul_f32 v55, v26, v55
  v_mul_f32 v56, v26, v56
  v_mul_f32 v57, v26, v57
  v_mul_f32_e64 v58, v26, v58
  v_mfma_f32_32x32x16_bf16 v[192:207], v[148:151], v[96:99], v[192:207]
  ds_read_b64_tr_b16 v[160:161], v13 offset:49152
  ds_read_b64_tr_b16 v[162:163], v13 offset:50176
  ds_read_b64_tr_b16 v[164:165], v16 offset:49152
  ds_read_b64_tr_b16 v[166:167], v16 offset:50176
  v_mul_f32 v59, v26, v59
  v_mul_f32 v60, v26, v60
  v_mul_f32 v61, v26, v61
  v_mul_f32 v62, v26, v62
  v_mul_f32 v63, v26, v63
  s_waitcnt vmcnt(9) lgkmcnt(4)
  v_mfma_f32_32x32x16_bf16 v[176:191], v[152:155], v[100:103], v[176:191]
  s_add_u32 s65, s5, 7
  s_and_b32 s65, s65, 7
  s_lshl_b32 s65, s65, 12
  s_add_u32 s65, s65, 1261568
  buffer_load_dwordx4 v[140:143], v18, s[48:51], s65 offen sc1
  v_sub_f32 v27, 1.0, v25
  v_mul_f32 v64, v27, v64
  v_mul_f32 v65, v27, v65
  v_mfma_f32_32x32x16_bf16 v[192:207], v[156:159], v[100:103], v[192:207]
  ds_read_b64_tr_b16 v[144:145], v13 offset:57344
  ds_read_b64_tr_b16 v[146:147], v13 offset:58368
  ds_read_b64_tr_b16 v[148:149], v16 offset:57344
  ds_read_b64_tr_b16 v[150:151], v16 offset:58368
  v_mul_f32 v66, v27, v66
  v_mul_f32 v67, v27, v67
  v_mul_f32 v68, v27, v68
  v_mul_f32_e64 v69, v27, v69
  s_waitcnt vmcnt(9) lgkmcnt(4)
  v_mfma_f32_32x32x16_bf16 v[176:191], v[160:163], v[104:107], v[176:191]
  v_mul_f32 v70, v27, v70
  v_mul_f32 v71, v27, v71
  v_mul_f32 v72, v27, v72
  v_mul_f32 v73, v27, v73
  v_mfma_f32_32x32x16_bf16 v[192:207], v[164:167], v[104:107], v[192:207]
  ds_read_b64_tr_b16 v[152:153], v12 offset:32768
  ds_read_b64_tr_b16 v[154:155], v12 offset:33792
  ds_read_b64_tr_b16 v[156:157], v15 offset:32768
  ds_read_b64_tr_b16 v[158:159], v15 offset:33792
  v_mul_f32 v74, v27, v74
  v_mul_f32 v75, v27, v75
  v_mul_f32 v76, v27, v76
  v_mul_f32 v77, v27, v77
  v_mul_f32 v78, v27, v78
  s_waitcnt vmcnt(8) lgkmcnt(4)
  v_mfma_f32_32x32x16_bf16 v[176:191], v[144:147], v[108:111], v[176:191]
  v_mul_f32 v79, v27, v79
  v_mul_f32 v80, v27, v80
  v_mul_f32 v81, v27, v81
  v_mul_f32 v82, v27, v82
  v_mfma_f32_32x32x16_bf16 v[192:207], v[148:151], v[108:111], v[192:207]
  ds_read_b64_tr_b16 v[160:161], v12 offset:0
  ds_read_b64_tr_b16 v[162:163], v12 offset:1024
  ds_read_b64_tr_b16 v[164:165], v15 offset:0
  ds_read_b64_tr_b16 v[166:167], v15 offset:1024
  v_mul_f32 v83, v27, v83
  v_mul_f32 v84, v27, v84
  v_mul_f32 v85, v27, v85
  v_mul_f32_e64 v86, v27, v86
  s_waitcnt vmcnt(7) lgkmcnt(4)
  v_mfma_f32_32x32x16_bf16 v[208:223], v[152:155], v[112:115], 0
  v_mul_f32 v87, v27, v87
  v_mul_f32 v88, v27, v88
  v_mul_f32 v89, v27, v89
  v_mul_f32 v90, v27, v90
  v_mfma_f32_32x32x16_bf16 v[224:239], v[156:159], v[112:115], 0
  ds_read_b64_tr_b16 v[144:145], v12 offset:8192
  ds_read_b64_tr_b16 v[146:147], v12 offset:9216
  ds_read_b64_tr_b16 v[148:149], v15 offset:8192
  ds_read_b64_tr_b16 v[150:151], v15 offset:9216
  v_mul_f32 v91, v27, v91
  v_mul_f32 v92, v27, v92
  v_mul_f32 v93, v27, v93
  v_mul_f32 v94, v27, v94
  v_mul_f32 v95, v27, v95
  s_waitcnt vmcnt(6) lgkmcnt(4)
  v_mfma_f32_32x32x16_bf16 v[208:223], v[160:163], v[116:119], v[208:223]
  v_xor_b32 v28, 0, v23
  v_fmac_f32 v32, v24, v176
  v_fmac_f32_e64 v33, v24, v177
  v_mfma_f32_32x32x16_bf16 v[224:239], v[164:167], v[116:119], v[224:239]
  ds_read_b64_tr_b16 v[152:153], v12 offset:16384
  ds_read_b64_tr_b16 v[154:155], v12 offset:17408
  ds_read_b64_tr_b16 v[156:157], v15 offset:16384
  ds_read_b64_tr_b16 v[158:159], v15 offset:17408
  v_fmac_f32 v34, v24, v178
  v_fmac_f32 v35, v24, v179
  ds_write_b128 v28, v[32:35] offset:0
  s_waitcnt vmcnt(5) lgkmcnt(5)
  v_mfma_f32_32x32x16_bf16 v[208:223], v[144:147], v[120:123], v[208:223]
  v_xor_b32 v29, 32, v23
  v_fmac_f32 v36, v24, v180
  v_fmac_f32 v37, v24, v181
  v_mfma_f32_32x32x16_bf16 v[224:239], v[148:151], v[120:123], v[224:239]
  ds_read_b64_tr_b16 v[160:161], v12 offset:24576
  ds_read_b64_tr_b16 v[162:163], v12 offset:25600
  ds_read_b64_tr_b16 v[164:165], v15 offset:24576
  ds_read_b64_tr_b16 v[166:167], v15 offset:25600
  v_fmac_f32 v38, v24, v182
  v_fmac_f32 v39, v24, v183
  ds_write_b128 v29, v[36:39] offset:0
  v_xor_b32 v28, 64, v23
  s_waitcnt vmcnt(4) lgkmcnt(6)
  v_mfma_f32_32x32x16_bf16 v[208:223], v[152:155], v[124:127], v[208:223]
  v_fmac_f32 v40, v24, v184
  v_fmac_f32 v41, v24, v185
  v_fmac_f32_e64 v42, v24, v186
  v_mfma_f32_32x32x16_bf16 v[224:239], v[156:159], v[124:127], v[224:239]
  ds_read_b64_tr_b16 v[144:145], v13 offset:40960
  ds_read_b64_tr_b16 v[146:147], v13 offset:41984
  ds_read_b64_tr_b16 v[148:149], v16 offset:40960
  ds_read_b64_tr_b16 v[150:151], v16 offset:41984
  v_fmac_f32_e64 v43, v24, v187
  ds_write_b128 v28, v[40:43] offset:0
  v_xor_b32 v29, 96, v23
  v_fmac_f32 v44, v24, v188
  s_waitcnt vmcnt(3) lgkmcnt(6)
  v_mfma_f32_32x32x16_bf16 v[208:223], v[160:163], v[128:131], v[208:223]
  v_fmac_f32 v45, v24, v189
  v_fmac_f32 v46, v24, v190
  v_fmac_f32_e64 v47, v24, v191
  v_mfma_f32_32x32x16_bf16 v[224:239], v[164:167], v[128:131], v[224:239]
  ds_read_b64_tr_b16 v[152:153], v13 offset:49152
  ds_read_b64_tr_b16 v[154:155], v13 offset:50176
  ds_read_b64_tr_b16 v[156:157], v16 offset:49152
  ds_read_b64_tr_b16 v[158:159], v16 offset:50176
  ds_write_b128 v29, v[44:47] offset:0
  v_xor_b32 v28, 128, v23
  v_fmac_f32 v48, v24, v192
  v_fmac_f32_e64 v49, v24, v193
  s_waitcnt vmcnt(2) lgkmcnt(6)
  v_mfma_f32_32x32x16_bf16 v[208:223], v[144:147], v[132:135], v[208:223]
  v_fmac_f32 v50, v24, v194
  v_fmac_f32 v51, v24, v195
  ds_write_b128 v28, v[48:51] offset:0
  v_mfma_f32_32x32x16_bf16 v[224:239], v[148:151], v[132:135], v[224:239]
  ds_read_b64_tr_b16 v[160:161], v13 offset:57344
  ds_read_b64_tr_b16 v[162:163], v13 offset:58368
  ds_read_b64_tr_b16 v[164:165], v16 offset:57344
  ds_read_b64_tr_b16 v[166:167], v16 offset:58368
  v_xor_b32 v29, 160, v23
  v_fmac_f32 v52, v24, v196
  v_fmac_f32 v53, v24, v197
  v_fmac_f32 v54, v24, v198
  s_waitcnt vmcnt(1) lgkmcnt(6)
  v_mfma_f32_32x32x16_bf16 v[208:223], v[152:155], v[136:139], v[208:223]
  v_fmac_f32_e64 v55, v24, v199
  ds_write_b128 v29, v[52:55] offset:0
  v_xor_b32 v28, 192, v23
  v_mfma_f32_32x32x16_bf16 v[224:239], v[156:159], v[136:139], v[224:239]
  v_fmac_f32 v56, v24, v200
  v_fmac_f32 v57, v24, v201
  v_fmac_f32 v58, v24, v202
  v_fmac_f32_e64 v59, v24, v203
  s_waitcnt vmcnt(0) lgkmcnt(1)
  v_mfma_f32_32x32x16_bf16 v[208:223], v[160:163], v[140:143], v[208:223]
  ds_write_b128 v28, v[56:59] offset:0
  v_xor_b32 v29, 224, v23
  v_fmac_f32_e64 v60, v24, v204
  v_mfma_f32_32x32x16_bf16 v[224:239], v[164:167], v[140:143], v[224:239]
  v_fmac_f32 v61, v24, v205
  v_fmac_f32 v62, v24, v206
  v_fmac_f32_e64 v63, v24, v207
  ds_write_b128 v29, v[60:63] offset:0
  s_waitcnt lgkmcnt(0)
  s_barrier
  s_nop 3
  v_xor_b32 v28, 0, v23
  v_fmac_f32 v64, v25, v208
  v_fmac_f32 v65, v25, v209
  v_fmac_f32 v66, v25, v210
  v_fmac_f32 v67, v25, v211
  ds_write_b128 v28, v[64:67] offset:32768
  v_xor_b32 v29, 32, v23
  v_fmac_f32 v68, v25, v212
  v_fmac_f32 v69, v25, v213
  v_fmac_f32 v70, v25, v214
  v_fmac_f32_e64 v71, v25, v215
  ds_write_b128 v29, v[68:71] offset:32768
  v_xor_b32 v28, 64, v23
  v_fmac_f32 v72, v25, v216
  v_fmac_f32 v73, v25, v217
  v_fmac_f32 v74, v25, v218
  v_fmac_f32_e64 v75, v25, v219
  ds_write_b128 v28, v[72:75] offset:32768
  v_xor_b32 v29, 96, v23
  v_fmac_f32 v76, v25, v220
  v_fmac_f32 v77, v25, v221
  v_fmac_f32 v78, v25, v222
  v_fmac_f32 v79, v25, v223
  ds_write_b128 v29, v[76:79] offset:32768
  v_xor_b32 v28, 128, v23
  v_fmac_f32 v80, v25, v224
  v_fmac_f32 v81, v25, v225
  v_fmac_f32 v82, v25, v226
  v_fmac_f32 v83, v25, v227
  ds_write_b128 v28, v[80:83] offset:32768
  v_xor_b32 v29, 160, v23
  v_fmac_f32 v84, v25, v228
  v_fmac_f32 v85, v25, v229
  v_fmac_f32 v86, v25, v230
  v_fmac_f32 v87, v25, v231
  ds_write_b128 v29, v[84:87] offset:32768
  v_xor_b32 v28, 192, v23
  v_fmac_f32 v88, v25, v232
  v_fmac_f32 v89, v25, v233
  v_fmac_f32 v90, v25, v234
  v_fmac_f32 v91, v25, v235
  ds_write_b128 v28, v[88:91] offset:32768
  v_xor_b32 v29, 224, v23
  v_fmac_f32 v92, v25, v236
  v_fmac_f32 v93, v25, v237
  v_fmac_f32 v94, v25, v238
  v_fmac_f32 v95, v25, v239
  ds_write_b128 v29, v[92:95] offset:32768
  s_waitcnt lgkmcnt(0)
  s_barrier
  s_endpgm
L_m:
  s_load_dword s68, s[28:29], 0
  s_lshl_b32 s64, s72, 2
  s_lshr_b32 s74, s73, 3
  s_add_u32 s64, s64, s74
  s_and_b32 s74, s73, 1
  s_lshl_b32 s74, s74, 1
  s_xor_b32 s64, s64, s74
  s_and_b32 s30, s73, 7
  s_lshl_b32 s30, s30, 7
  s_mov_b32 s78, 0x3fb8aa3b
  s_mov_b32 s48, s28
  s_mov_b32 s49, s29
  s_mov_b32 s50, 33554432
  s_mov_b32 s51, 0x20000
  s_mov_b32 s52, s24
  s_mov_b32 s53, s25
  s_mov_b32 s54, 2097152
  s_mov_b32 s55, 0x20000
  v_and_b32 v28, 31, v0
  v_bfe_u32 v29, v0, 1, 3
  v_lshrrev_b32 v30, 5, v0
  v_lshlrev_b32 v30, 1, v30
  v_xor_b32 v29, v29, v30
  v_lshlrev_b32 v29, 4, v29
  v_lshl_add_u32 v2, v28, 7, v29
  v_and_b32 v28, 3, v0
  v_lshlrev_b32 v28, 3, v28
  v_bfe_u32 v29, v0, 4, 1
  v_lshl_add_u32 v28, v29, 5, v28
  v_bfe_u32 v29, v0, 3, 1
  v_lshl_add_u32 v28, v29, 6, v28
  v_bfe_u32 v29, v0, 2, 2
  v_lshl_add_u32 v28, v29, 7, v28
  v_lshrrev_b32_e64 v29, 5, v0
  v_lshl_add_u32 v6, v29, 11, v28
  s_bitcmp1_b32 s73, 4
  s_cbranch_scc1 L_mf
  s_add_u32 s74, s67, 57344
  v_add_u32 v2, s74, v2
  v_xor_b32 v3, 16, v2
  v_xor_b32_e64 v4, 64, v2
  v_xor_b32 v5, 0x50, v2
  v_xor_b32 v7, 64, v6
  v_lshrrev_b32 v29, 5, v0
  v_bfe_u32 v28, v0, 2, 1
  v_cmp_eq_u32 s[76:77], v28, v29
  v_bfe_u32 v28, v0, 3, 2
  v_lshlrev_b32_e64 v28, 1, v28
  v_bfe_u32 v29, v0, 1, 1
  v_add_u32 v28, v28, v29
  v_and_b32 v29, 1, v0
  v_lshlrev_b32_e64 v29, 4, v29
  v_mov_b32 v30, 0x3f80
  v_lshlrev_b32_e64 v30, v29, v30
  v_cndmask_b32 v30, 0, v30, s[76:77]
  v_cmp_eq_u32 vcc, 0, v28
  s_nop 1
  v_cndmask_b32 v8, 0, v30, vcc
  v_cmp_eq_u32 vcc, 1, v28
  s_nop 1
  v_cndmask_b32 v9, 0, v30, vcc
  v_cmp_eq_u32 vcc, 2, v28
  s_nop 1
  v_cndmask_b32 v10, 0, v30, vcc
  v_cmp_eq_u32 vcc, 3, v28
  s_nop 1
  v_cndmask_b32 v11, 0, v30, vcc
  v_cmp_eq_u32 vcc, 4, v28
  s_nop 1
  v_cndmask_b32 v12, 0, v30, vcc
  v_cmp_eq_u32 vcc, 5, v28
  s_nop 1
  v_cndmask_b32 v13, 0, v30, vcc
  v_cmp_eq_u32 vcc, 6, v28
  s_nop 1
  v_cndmask_b32 v14, 0, v30, vcc
  v_cmp_eq_u32 vcc, 7, v28
  s_nop 1
  v_cndmask_b32 v15, 0, v30, vcc
  v_lshrrev_b32 v28, 2, v0
  v_xor_b32 v28, v28, v0
  v_and_b32 v28, 4, v28
  v_cmp_eq_u32 vcc, 0, v28
  v_mov_b32 v29, 0x3f803f80
  s_nop 0
  v_cndmask_b32 v16, 0, v29, vcc
  v_cndmask_b32 v17, 0, v29, vcc
  v_cndmask_b32 v18, 0, v29, vcc
  v_cndmask_b32_e64 v19, 0, v29, vcc
  s_mov_b32 s76, 0xffff0000
  s_mov_b32 s77, 0xffff0000
  v_lshrrev_b32 v30, 5, v0
  v_lshlrev_b32 v29, 7, v30
  v_bfe_u32 v28, v0, 2, 1
  v_lshl_add_u32 v29, v28, 6, v29
  v_bfe_u32 v28, v0, 3, 2
  v_lshl_add_u32 v29, v28, 4, v29
  v_and_b32_e64 v28, 3, v0
  v_lshl_add_u32 v29, v28, 2, v29
  s_lshl_b32 s74, s63, 9
  s_add_u32 s74, s74, 161792
  v_add_u32 v31, s74, v29
  v_bfe_u32 v28, v0, 1, 2
  v_xor_b32 v29, v0, v30
  v_and_b32 v29, 1, v29
  v_lshl_add_u32 v28, v29, 2, v28
  v_lshlrev_b32 v28, 4, v28
  v_and_b32 v29, 31, v0
  v_lshl_add_u32 v28, v29, 7, v28
  s_lshl_b32 s74, s63, 13
  s_add_u32 s74, s74, 57344
  v_add_u32 v30, s74, v28
  v_bfe_u32 v28, v0, 2, 2
  v_lshlrev_b32_e64 v28, 5, v28
  v_bfe_u32 v29, v0, 4, 1
  v_lshl_add_u32 v28, v29, 4, v28
  v_bfe_u32 v29, v0, 1, 1
  v_lshl_add_u32 v28, v29, 3, v28
  v_lshrrev_b32_e64 v29, 5, v0
  v_lshl_add_u32 v28, v29, 7, v28
  v_add_u32 v28, 155648, v28
  v_bfe_u32 v29, v0, 2, 1
  v_mul_u32_u24 v29, 0x8000, v29
  v_lshl_add_u32 v29, v29, 16, v29
  s_lshl2_add_u32 s74, s61, s63
  s_mul_i32 s31, s74, 122880
  s_lshl_b32 s75, s62, 12
  s_add_u32 s31, s31, s75
  s_add_u32 s31, s31, 1138688
  s_lshr_b32 s12, s74, 1
  s_lshl_b32 s12, s12, 5
  s_and_b32 s74, s74, 1
  s_add_u32 s12, s12, s74
  s_lshl1_add_u32 s12, s62, s12
  s_lshl_b32 s12, s12, 7
  s_add_u32 s12, s12, 854016
  s_waitcnt vmcnt(0) lgkmcnt(0)
  s_mul_i32 s68, s68, 1664525
  s_add_u32 s68, s68, 1013904223
  s_xor_b32 s69, s68, 0x9e3779b9
  s_barrier
  ds_read_b128 v[128:131], v2 offset:16384
  ds_read_b64_tr_b16 v[96:97], v6 offset:0
  ds_read_b64_tr_b16 v[98:99], v6 offset:512
  ds_read_b64_tr_b16 v[100:101], v7 offset:0
  ds_read_b64_tr_b16 v[102:103], v7 offset:512
  ds_read_b64_tr_b16 v[104:105], v6 offset:8192
  ds_read_b64_tr_b16 v[106:107], v6 offset:8704
  ds_read_b64_tr_b16 v[108:109], v7 offset:8192
  ds_read_b64_tr_b16 v[110:111], v7 offset:8704
  ds_read_b128 v[132:135], v3 offset:16384
  ds_read_b64_tr_b16 v[112:113], v6 offset:1024
  ds_read_b64_tr_b16 v[114:115], v6 offset:1536
  ds_read_b64_tr_b16 v[116:117], v7 offset:1024
  ds_read_b64_tr_b16 v[118:119], v7 offset:1536
  ds_read_b64_tr_b16 v[120:121], v6 offset:9216
  ds_read_b64_tr_b16 v[122:123], v6 offset:9728
  ds_read_b64_tr_b16 v[124:125], v7 offset:9216
  ds_read_b64_tr_b16 v[126:127], v7 offset:9728
  s_waitcnt lgkmcnt(15)
  v_mfma_f32_32x32x16_bf16 v[32:47], v[96:99], v[128:131], 0
  ds_read_b128 v[136:139], v4 offset:16384
  ds_read_b64_tr_b16 v[96:97], v6 offset:4096
  ds_read_b64_tr_b16 v[98:99], v6 offset:4608
  s_waitcnt lgkmcnt(15)
  v_mfma_f32_32x32x16_bf16 v[48:63], v[100:103], v[128:131], 0
  ds_read_b64_tr_b16 v[100:101], v7 offset:4096
  ds_read_b64_tr_b16 v[102:103], v7 offset:4608
  s_waitcnt lgkmcnt(15)
  v_mfma_f32_32x32x16_bf16 v[64:79], v[128:131], v[104:107], 0
  ds_read_b64_tr_b16 v[104:105], v6 offset:12288
  ds_read_b64_tr_b16 v[106:107], v6 offset:12800
  s_waitcnt lgkmcnt(15)
  v_mfma_f32_32x32x16_bf16 v[80:95], v[128:131], v[108:111], 0
  ds_read_b64_tr_b16 v[108:109], v7 offset:12288
  ds_read_b64_tr_b16 v[110:111], v7 offset:12800
  s_waitcnt lgkmcnt(15)
  v_mfma_f32_32x32x16_bf16 v[32:47], v[112:115], v[132:135], v[32:47]
  ds_read_b128 v[140:143], v5 offset:16384
  ds_read_b64_tr_b16 v[112:113], v6 offset:5120
  ds_read_b64_tr_b16 v[114:115], v6 offset:5632
  s_waitcnt lgkmcnt(15)
  v_mfma_f32_32x32x16_bf16 v[48:63], v[116:119], v[132:135], v[48:63]
  ds_read_b64_tr_b16 v[116:117], v7 offset:5120
  ds_read_b64_tr_b16 v[118:119], v7 offset:5632
  s_waitcnt lgkmcnt(15)
  v_mfma_f32_32x32x16_bf16 v[64:79], v[132:135], v[120:123], v[64:79]
  ds_read_b64_tr_b16 v[120:121], v6 offset:13312
  ds_read_b64_tr_b16 v[122:123], v6 offset:13824
  s_waitcnt lgkmcnt(15)
  v_mfma_f32_32x32x16_bf16 v[80:95], v[132:135], v[124:127], v[80:95]
  ds_read_b64_tr_b16 v[124:125], v7 offset:13312
  ds_read_b64_tr_b16 v[126:127], v7 offset:13824
  s_waitcnt lgkmcnt(15)
  v_mfma_f32_32x32x16_bf16 v[32:47], v[96:99], v[136:139], v[32:47]
  s_waitcnt lgkmcnt(13)
  v_mfma_f32_32x32x16_bf16 v[48:63], v[100:103], v[136:139], v[48:63]
  s_waitcnt lgkmcnt(0)
  s_barrier
  ds_read_b128 v[144:147], v2 offset:32768
  ds_read_b64_tr_b16 v[96:97], v6 offset:16384
  ds_read_b64_tr_b16 v[98:99], v6 offset:16896
  ds_read_b64_tr_b16 v[100:101], v7 offset:16384
  v_mfma_f32_32x32x16_bf16 v[64:79], v[136:139], v[104:107], v[64:79]
  ds_read_b64_tr_b16 v[102:103], v7 offset:16896
  ds_read_b64_tr_b16 v[104:105], v6 offset:24576
  ds_read_b64_tr_b16 v[106:107], v6 offset:25088
  v_mfma_f32_32x32x16_bf16 v[80:95], v[136:139], v[108:111], v[80:95]
  ds_read_b64_tr_b16 v[108:109], v7 offset:24576
  ds_read_b64_tr_b16 v[110:111], v7 offset:25088
  v_mfma_f32_32x32x16_bf16 v[32:47], v[112:115], v[140:143], v[32:47]
  ds_read_b128 v[148:151], v3 offset:32768
  ds_read_b64_tr_b16 v[112:113], v6 offset:17408
  ds_read_b64_tr_b16 v[114:115], v6 offset:17920
  v_mfma_f32_32x32x16_bf16 v[48:63], v[116:119], v[140:143], v[48:63]
  ds_read_b64_tr_b16 v[116:117], v7 offset:17408
  ds_read_b64_tr_b16 v[118:119], v7 offset:17920
  v_mfma_f32_32x32x16_bf16 v[64:79], v[140:143], v[120:123], v[64:79]
  ds_read_b64_tr_b16 v[120:121], v6 offset:25600
  ds_read_b64_tr_b16 v[122:123], v6 offset:26112
  v_mfma_f32_32x32x16_bf16 v[80:95], v[140:143], v[124:127], v[80:95]
  ds_read_b64_tr_b16 v[124:125], v7 offset:25600
  ds_read_b64_tr_b16 v[126:127], v7 offset:26112
  s_waitcnt lgkmcnt(15)
  v_mfma_f32_32x32x16_bf16 v[32:47], v[96:99], v[144:147], v[32:47]
  ds_read_b128 v[152:155], v4 offset:32768
  ds_read_b64_tr_b16 v[96:97], v6 offset:20480
  ds_read_b64_tr_b16 v[98:99], v6 offset:20992
  s_waitcnt lgkmcnt(15)
  v_mfma_f32_32x32x16_bf16 v[48:63], v[100:103], v[144:147], v[48:63]
  ds_read_b64_tr_b16 v[100:101], v7 offset:20480
  ds_read_b64_tr_b16 v[102:103], v7 offset:20992
  s_waitcnt lgkmcnt(15)
  v_mfma_f32_32x32x16_bf16 v[64:79], v[144:147], v[104:107], v[64:79]
  ds_read_b64_tr_b16 v[104:105], v6 offset:28672
  ds_read_b64_tr_b16 v[106:107], v6 offset:29184
  s_waitcnt lgkmcnt(15)
  v_mfma_f32_32x32x16_bf16 v[80:95], v[144:147], v[108:111], v[80:95]
  ds_read_b64_tr_b16 v[108:109], v7 offset:28672
  ds_read_b64_tr_b16 v[110:111], v7 offset:29184
  s_waitcnt lgkmcnt(15)
  v_mfma_f32_32x32x16_bf16 v[32:47], v[112:115], v[148:151], v[32:47]
  ds_read_b128 v[156:159], v5 offset:32768
  ds_read_b64_tr_b16 v[112:113], v6 offset:21504
  ds_read_b64_tr_b16 v[114:115], v6 offset:22016
  s_waitcnt lgkmcnt(15)
  v_mfma_f32_32x32x16_bf16 v[48:63], v[116:119], v[148:151], v[48:63]
  ds_read_b64_tr_b16 v[116:117], v7 offset:21504
  ds_read_b64_tr_b16 v[118:119], v7 offset:22016
  s_waitcnt lgkmcnt(15)
  v_mfma_f32_32x32x16_bf16 v[64:79], v[148:151], v[120:123], v[64:79]
  ds_read_b64_tr_b16 v[120:121], v6 offset:29696
  ds_read_b64_tr_b16 v[122:123], v6 offset:30208
  s_waitcnt lgkmcnt(15)
  v_mfma_f32_32x32x16_bf16 v[80:95], v[148:151], v[124:127], v[80:95]
  ds_read_b64_tr_b16 v[124:125], v7 offset:29696
  ds_read_b64_tr_b16 v[126:127], v7 offset:30208
  s_waitcnt lgkmcnt(15)
  v_mfma_f32_32x32x16_bf16 v[32:47], v[96:99], v[152:155], v[32:47]
  s_waitcnt lgkmcnt(13)
  v_mfma_f32_32x32x16_bf16 v[48:63], v[100:103], v[152:155], v[48:63]
  s_waitcnt lgkmcnt(0)
  s_barrier
  ds_read_b128 v[160:163], v2 offset:0
  ds_read_b64_tr_b16 v[96:97], v6 offset:32768
  ds_read_b64_tr_b16 v[98:99], v6 offset:33280
  ds_read_b64_tr_b16 v[100:101], v7 offset:32768
  v_mfma_f32_32x32x16_bf16 v[64:79], v[152:155], v[104:107], v[64:79]
  ds_read_b64_tr_b16 v[102:103], v7 offset:33280
  ds_read_b64_tr_b16 v[104:105], v6 offset:40960
  ds_read_b64_tr_b16 v[106:107], v6 offset:41472
  v_mfma_f32_32x32x16_bf16 v[80:95], v[152:155], v[108:111], v[80:95]
  ds_read_b64_tr_b16 v[108:109], v7 offset:40960
  ds_read_b64_tr_b16 v[110:111], v7 offset:41472
  v_mfma_f32_32x32x16_bf16 v[32:47], v[112:115], v[156:159], v[32:47]
  ds_read_b128 v[164:167], v3 offset:0
  ds_read_b64_tr_b16 v[112:113], v6 offset:33792
  ds_read_b64_tr_b16 v[114:115], v6 offset:34304
  v_mfma_f32_32x32x16_bf16 v[48:63], v[116:119], v[156:159], v[48:63]
  ds_read_b64_tr_b16 v[116:117], v7 offset:33792
  ds_read_b64_tr_b16 v[118:119], v7 offset:34304
  v_mfma_f32_32x32x16_bf16 v[64:79], v[156:159], v[120:123], v[64:79]
  ds_read_b64_tr_b16 v[120:121], v6 offset:41984
  ds_read_b64_tr_b16 v[122:123], v6 offset:42496
  v_mfma_f32_32x32x16_bf16 v[80:95], v[156:159], v[124:127], v[80:95]
  ds_read_b64_tr_b16 v[124:125], v7 offset:41984
  ds_read_b64_tr_b16 v[126:127], v7 offset:42496
  s_waitcnt lgkmcnt(15)
  v_mfma_f32_32x32x16_bf16 v[32:47], v[96:99], v[160:163], v[32:47]
  ds_read_b128 v[168:171], v4 offset:0
  ds_read_b64_tr_b16 v[96:97], v6 offset:36864
  ds_read_b64_tr_b16 v[98:99], v6 offset:37376
  s_waitcnt lgkmcnt(15)
  v_mfma_f32_32x32x16_bf16 v[48:63], v[100:103], v[160:163], v[48:63]
  ds_read_b64_tr_b16 v[100:101], v7 offset:36864
  ds_read_b64_tr_b16 v[102:103], v7 offset:37376
  s_waitcnt lgkmcnt(15)
  v_mfma_f32_32x32x16_bf16 v[64:79], v[160:163], v[104:107], v[64:79]
  ds_read_b64_tr_b16 v[104:105], v6 offset:45056
  ds_read_b64_tr_b16 v[106:107], v6 offset:45568
  s_waitcnt lgkmcnt(15)
  v_mfma_f32_32x32x16_bf16 v[80:95], v[160:163], v[108:111], v[80:95]
  ds_read_b64_tr_b16 v[108:109], v7 offset:45056
  ds_read_b64_tr_b16 v[110:111], v7 offset:45568
  s_waitcnt lgkmcnt(15)
  v_mfma_f32_32x32x16_bf16 v[32:47], v[112:115], v[164:167], v[32:47]
  ds_read_b128 v[172:175], v5 offset:0
  ds_read_b64_tr_b16 v[112:113], v6 offset:37888
  ds_read_b64_tr_b16 v[114:115], v6 offset:38400
  s_waitcnt lgkmcnt(15)
  v_mfma_f32_32x32x16_bf16 v[48:63], v[116:119], v[164:167], v[48:63]
  ds_read_b64_tr_b16 v[116:117], v7 offset:37888
  ds_read_b64_tr_b16 v[118:119], v7 offset:38400
  s_waitcnt lgkmcnt(15)
  v_mfma_f32_32x32x16_bf16 v[64:79], v[164:167], v[120:123], v[64:79]
  ds_read_b64_tr_b16 v[120:121], v6 offset:46080
  ds_read_b64_tr_b16 v[122:123], v6 offset:46592
  s_waitcnt lgkmcnt(15)
  v_mfma_f32_32x32x16_bf16 v[80:95], v[164:167], v[124:127], v[80:95]
  ds_read_b64_tr_b16 v[124:125], v7 offset:46080
  ds_read_b64_tr_b16 v[126:127], v7 offset:46592
  s_waitcnt lgkmcnt(15)
  v_mfma_f32_32x32x16_bf16 v[32:47], v[96:99], v[168:171], v[32:47]
  s_waitcnt lgkmcnt(13)
  v_mfma_f32_32x32x16_bf16 v[48:63], v[100:103], v[168:171], v[48:63]
  s_waitcnt lgkmcnt(0)
  s_barrier
  ds_read_b128 v[176:179], v2 offset:16384
  ds_read_b64_tr_b16 v[96:97], v6 offset:0
  ds_read_b64_tr_b16 v[98:99], v6 offset:512
  ds_read_b64_tr_b16 v[100:101], v7 offset:0
  v_mfma_f32_32x32x16_bf16 v[64:79], v[168:171], v[104:107], v[64:79]
  ds_read_b64_tr_b16 v[102:103], v7 offset:512
  ds_read_b64_tr_b16 v[104:105], v6 offset:8192
  ds_read_b64_tr_b16 v[106:107], v6 offset:8704
  v_mfma_f32_32x32x16_bf16 v[80:95], v[168:171], v[108:111], v[80:95]
  ds_read_b64_tr_b16 v[108:109], v7 offset:8192
  ds_read_b64_tr_b16 v[110:111], v7 offset:8704
  v_mfma_f32_32x32x16_bf16 v[32:47], v[112:115], v[172:175], v[32:47]
  ds_read_b128 v[180:183], v3 offset:16384
  ds_read_b64_tr_b16 v[112:113], v6 offset:1024
  ds_read_b64_tr_b16 v[114:115], v6 offset:1536
  v_mfma_f32_32x32x16_bf16 v[48:63], v[116:119], v[172:175], v[48:63]
  ds_read_b64_tr_b16 v[116:117], v7 offset:1024
  ds_read_b64_tr_b16 v[118:119], v7 offset:1536
  v_mfma_f32_32x32x16_bf16 v[64:79], v[172:175], v[120:123], v[64:79]
  ds_read_b64_tr_b16 v[120:121], v6 offset:9216
  ds_read_b64_tr_b16 v[122:123], v6 offset:9728
  v_mfma_f32_32x32x16_bf16 v[80:95], v[172:175], v[124:127], v[80:95]
  ds_read_b64_tr_b16 v[124:125], v7 offset:9216
  ds_read_b64_tr_b16 v[126:127], v7 offset:9728
  s_waitcnt lgkmcnt(15)
  v_mfma_f32_32x32x16_bf16 v[32:47], v[96:99], v[176:179], v[32:47]
  ds_read_b128 v[184:187], v4 offset:16384
  ds_read_b64_tr_b16 v[96:97], v6 offset:4096
  ds_read_b64_tr_b16 v[98:99], v6 offset:4608
  s_waitcnt lgkmcnt(15)
  v_mfma_f32_32x32x16_bf16 v[48:63], v[100:103], v[176:179], v[48:63]
  ds_read_b64_tr_b16 v[100:101], v7 offset:4096
  ds_read_b64_tr_b16 v[102:103], v7 offset:4608
  s_waitcnt lgkmcnt(15)
  v_mfma_f32_32x32x16_bf16 v[64:79], v[176:179], v[104:107], v[64:79]
  ds_read_b64_tr_b16 v[104:105], v6 offset:12288
  ds_read_b64_tr_b16 v[106:107], v6 offset:12800
  s_waitcnt lgkmcnt(15)
  v_mfma_f32_32x32x16_bf16 v[80:95], v[176:179], v[108:111], v[80:95]
  ds_read_b64_tr_b16 v[108:109], v7 offset:12288
  ds_read_b64_tr_b16 v[110:111], v7 offset:12800
  s_waitcnt lgkmcnt(15)
  v_mfma_f32_32x32x16_bf16 v[32:47], v[112:115], v[180:183], v[32:47]
  ds_read_b128 v[188:191], v5 offset:16384
  ds_read_b64_tr_b16 v[112:113], v6 offset:5120
  ds_read_b64_tr_b16 v[114:115], v6 offset:5632
  s_waitcnt lgkmcnt(15)
  v_mfma_f32_32x32x16_bf16 v[48:63], v[116:119], v[180:183], v[48:63]
  ds_read_b64_tr_b16 v[116:117], v7 offset:5120
  ds_read_b64_tr_b16 v[118:119], v7 offset:5632
  s_waitcnt lgkmcnt(15)
  v_mfma_f32_32x32x16_bf16 v[64:79], v[180:183], v[120:123], v[64:79]
  ds_read_b64_tr_b16 v[120:121], v6 offset:13312
  ds_read_b64_tr_b16 v[122:123], v6 offset:13824
  s_waitcnt lgkmcnt(15)
  v_mfma_f32_32x32x16_bf16 v[80:95], v[180:183], v[124:127], v[80:95]
  ds_read_b64_tr_b16 v[124:125], v7 offset:13312
  ds_read_b64_tr_b16 v[126:127], v7 offset:13824
  s_waitcnt lgkmcnt(15)
  v_mfma_f32_32x32x16_bf16 v[32:47], v[96:99], v[184:187], v[32:47]
  s_waitcnt lgkmcnt(13)
  v_mfma_f32_32x32x16_bf16 v[48:63], v[100:103], v[184:187], v[48:63]
  s_waitcnt lgkmcnt(0)
  s_barrier
  ds_read_b128 v[192:195], v2 offset:32768
  ds_read_b64_tr_b16 v[96:97], v6 offset:16384
  ds_read_b64_tr_b16 v[98:99], v6 offset:16896
  ds_read_b64_tr_b16 v[100:101], v7 offset:16384
  v_mfma_f32_32x32x16_bf16 v[64:79], v[184:187], v[104:107], v[64:79]
  ds_read_b64_tr_b16 v[102:103], v7 offset:16896
  ds_read_b64_tr_b16 v[104:105], v6 offset:24576
  ds_read_b64_tr_b16 v[106:107], v6 offset:25088
  v_mfma_f32_32x32x16_bf16 v[80:95], v[184:187], v[108:111], v[80:95]
  ds_read_b64_tr_b16 v[108:109], v7 offset:24576
  ds_read_b64_tr_b16 v[110:111], v7 offset:25088
  v_mfma_f32_32x32x16_bf16 v[32:47], v[112:115], v[188:191], v[32:47]
  ds_read_b128 v[196:199], v3 offset:32768
  ds_read_b64_tr_b16 v[112:113], v6 offset:17408
  ds_read_b64_tr_b16 v[114:115], v6 offset:17920
  v_mfma_f32_32x32x16_bf16 v[48:63], v[116:119], v[188:191], v[48:63]
  ds_read_b64_tr_b16 v[116:117], v7 offset:17408
  ds_read_b64_tr_b16 v[118:119], v7 offset:17920
  v_mfma_f32_32x32x16_bf16 v[64:79], v[188:191], v[120:123], v[64:79]
  ds_read_b64_tr_b16 v[120:121], v6 offset:25600
  ds_read_b64_tr_b16 v[122:123], v6 offset:26112
  v_mfma_f32_32x32x16_bf16 v[80:95], v[188:191], v[124:127], v[80:95]
  ds_read_b64_tr_b16 v[124:125], v7 offset:25600
  ds_read_b64_tr_b16 v[126:127], v7 offset:26112
  s_waitcnt lgkmcnt(15)
  v_mfma_f32_32x32x16_bf16 v[32:47], v[96:99], v[192:195], v[32:47]
  ds_read_b128 v[200:203], v4 offset:32768
  ds_read_b64_tr_b16 v[96:97], v6 offset:20480
  ds_read_b64_tr_b16 v[98:99], v6 offset:20992
  s_waitcnt lgkmcnt(15)
  v_mfma_f32_32x32x16_bf16 v[48:63], v[100:103], v[192:195], v[48:63]
  ds_read_b64_tr_b16 v[100:101], v7 offset:20480
  ds_read_b64_tr_b16 v[102:103], v7 offset:20992
  s_waitcnt lgkmcnt(15)
  v_mfma_f32_32x32x16_bf16 v[64:79], v[192:195], v[104:107], v[64:79]
  ds_read_b64_tr_b16 v[104:105], v6 offset:28672
  ds_read_b64_tr_b16 v[106:107], v6 offset:29184
  s_waitcnt lgkmcnt(15)
  v_mfma_f32_32x32x16_bf16 v[80:95], v[192:195], v[108:111], v[80:95]
  ds_read_b64_tr_b16 v[108:109], v7 offset:28672
  ds_read_b64_tr_b16 v[110:111], v7 offset:29184
  s_waitcnt lgkmcnt(15)
  v_mfma_f32_32x32x16_bf16 v[32:47], v[112:115], v[196:199], v[32:47]
  ds_read_b128 v[204:207], v5 offset:32768
  ds_read_b64_tr_b16 v[112:113], v6 offset:21504
  ds_read_b64_tr_b16 v[114:115], v6 offset:22016
  s_waitcnt lgkmcnt(15)
  v_mfma_f32_32x32x16_bf16 v[48:63], v[116:119], v[196:199], v[48:63]
  ds_read_b64_tr_b16 v[116:117], v7 offset:21504
  ds_read_b64_tr_b16 v[118:119], v7 offset:22016
  s_waitcnt lgkmcnt(15)
  v_mfma_f32_32x32x16_bf16 v[64:79], v[196:199], v[120:123], v[64:79]
  ds_read_b64_tr_b16 v[120:121], v6 offset:29696
  ds_read_b64_tr_b16 v[122:123], v6 offset:30208
  s_waitcnt lgkmcnt(15)
  v_mfma_f32_32x32x16_bf16 v[80:95], v[196:199], v[124:127], v[80:95]
  ds_read_b64_tr_b16 v[124:125], v7 offset:29696
  ds_read_b64_tr_b16 v[126:127], v7 offset:30208
  s_waitcnt lgkmcnt(15)
  v_mfma_f32_32x32x16_bf16 v[32:47], v[96:99], v[200:203], v[32:47]
  s_waitcnt lgkmcnt(13)
  v_mfma_f32_32x32x16_bf16 v[48:63], v[100:103], v[200:203], v[48:63]
  s_waitcnt lgkmcnt(0)
  s_barrier
  ds_read_b128 v[208:211], v2 offset:0
  ds_read_b64_tr_b16 v[96:97], v6 offset:32768
  ds_read_b64_tr_b16 v[98:99], v6 offset:33280
  ds_read_b64_tr_b16 v[100:101], v7 offset:32768
  v_mfma_f32_32x32x16_bf16 v[64:79], v[200:203], v[104:107], v[64:79]
  ds_read_b64_tr_b16 v[102:103], v7 offset:33280
  ds_read_b64_tr_b16 v[104:105], v6 offset:40960
  ds_read_b64_tr_b16 v[106:107], v6 offset:41472
  v_mfma_f32_32x32x16_bf16 v[80:95], v[200:203], v[108:111], v[80:95]
  ds_read_b64_tr_b16 v[108:109], v7 offset:40960
  ds_read_b64_tr_b16 v[110:111], v7 offset:41472
  v_mfma_f32_32x32x16_bf16 v[32:47], v[112:115], v[204:207], v[32:47]
  ds_read_b128 v[212:215], v3 offset:0
  ds_read_b64_tr_b16 v[112:113], v6 offset:33792
  ds_read_b64_tr_b16 v[114:115], v6 offset:34304
  v_mfma_f32_32x32x16_bf16 v[48:63], v[116:119], v[204:207], v[48:63]
  ds_read_b64_tr_b16 v[116:117], v7 offset:33792
  ds_read_b64_tr_b16 v[118:119], v7 offset:34304
  v_mfma_f32_32x32x16_bf16 v[64:79], v[204:207], v[120:123], v[64:79]
  ds_read_b64_tr_b16 v[120:121], v6 offset:41984
  ds_read_b64_tr_b16 v[122:123], v6 offset:42496
  v_mfma_f32_32x32x16_bf16 v[80:95], v[204:207], v[124:127], v[80:95]
  ds_read_b64_tr_b16 v[124:125], v7 offset:41984
  ds_read_b64_tr_b16 v[126:127], v7 offset:42496
  s_waitcnt lgkmcnt(15)
  v_mfma_f32_32x32x16_bf16 v[32:47], v[96:99], v[208:211], v[32:47]
  ds_read_b128 v[216:219], v4 offset:0
  ds_read_b64_tr_b16 v[96:97], v6 offset:36864
  ds_read_b64_tr_b16 v[98:99], v6 offset:37376
  s_waitcnt lgkmcnt(15)
  v_mfma_f32_32x32x16_bf16 v[48:63], v[100:103], v[208:211], v[48:63]
  ds_read_b64_tr_b16 v[100:101], v7 offset:36864
  ds_read_b64_tr_b16 v[102:103], v7 offset:37376
  s_waitcnt lgkmcnt(15)
  v_mfma_f32_32x32x16_bf16 v[64:79], v[208:211], v[104:107], v[64:79]
  ds_read_b64_tr_b16 v[104:105], v6 offset:45056
  ds_read_b64_tr_b16 v[106:107], v6 offset:45568
  s_waitcnt lgkmcnt(15)
  v_mfma_f32_32x32x16_bf16 v[80:95], v[208:211], v[108:111], v[80:95]
  ds_read_b64_tr_b16 v[108:109], v7 offset:45056
  ds_read_b64_tr_b16 v[110:111], v7 offset:45568
  s_waitcnt lgkmcnt(15)
  v_mfma_f32_32x32x16_bf16 v[32:47], v[112:115], v[212:215], v[32:47]
  ds_read_b128 v[220:223], v5 offset:0
  ds_read_b64_tr_b16 v[112:113], v6 offset:37888
  ds_read_b64_tr_b16 v[114:115], v6 offset:38400
  s_waitcnt lgkmcnt(15)
  v_mfma_f32_32x32x16_bf16 v[48:63], v[116:119], v[212:215], v[48:63]
  ds_read_b64_tr_b16 v[116:117], v7 offset:37888
  ds_read_b64_tr_b16 v[118:119], v7 offset:38400
  s_waitcnt lgkmcnt(15)
  v_mfma_f32_32x32x16_bf16 v[64:79], v[212:215], v[120:123], v[64:79]
  ds_read_b64_tr_b16 v[120:121], v6 offset:46080
  ds_read_b64_tr_b16 v[122:123], v6 offset:46592
  s_waitcnt lgkmcnt(15)
  v_mfma_f32_32x32x16_bf16 v[80:95], v[212:215], v[124:127], v[80:95]
  ds_read_b64_tr_b16 v[124:125], v7 offset:46080
  ds_read_b64_tr_b16 v[126:127], v7 offset:46592
  s_waitcnt lgkmcnt(15)
  v_mfma_f32_32x32x16_bf16 v[32:47], v[96:99], v[216:219], v[32:47]
  s_waitcnt lgkmcnt(13)
  v_mfma_f32_32x32x16_bf16 v[48:63], v[100:103], v[216:219], v[48:63]
  s_waitcnt lgkmcnt(0)
  s_barrier
  ds_read_b128 v[224:227], v2 offset:16384
  ds_read_b64_tr_b16 v[96:97], v6 offset:0
  ds_read_b64_tr_b16 v[98:99], v6 offset:512
  ds_read_b64_tr_b16 v[100:101], v7 offset:0
  v_mfma_f32_32x32x16_bf16 v[64:79], v[216:219], v[104:107], v[64:79]
  ds_read_b64_tr_b16 v[102:103], v7 offset:512
  ds_read_b64_tr_b16 v[104:105], v6 offset:8192
  ds_read_b64_tr_b16 v[106:107], v6 offset:8704
  v_mfma_f32_32x32x16_bf16 v[80:95], v[216:219], v[108:111], v[80:95]
  ds_read_b64_tr_b16 v[108:109], v7 offset:8192
  ds_read_b64_tr_b16 v[110:111], v7 offset:8704
  v_mfma_f32_32x32x16_bf16 v[32:47], v[112:115], v[220:223], v[32:47]
  ds_read_b128 v[228:231], v3 offset:16384
  ds_read_b64_tr_b16 v[112:113], v6 offset:1024
  ds_read_b64_tr_b16 v[114:115], v6 offset:1536
  v_mfma_f32_32x32x16_bf16 v[48:63], v[116:119], v[220:223], v[48:63]
  ds_read_b64_tr_b16 v[116:117], v7 offset:1024
  ds_read_b64_tr_b16 v[118:119], v7 offset:1536
  v_mfma_f32_32x32x16_bf16 v[64:79], v[220:223], v[120:123], v[64:79]
  ds_read_b64_tr_b16 v[120:121], v6 offset:9216
  ds_read_b64_tr_b16 v[122:123], v6 offset:9728
  v_mfma_f32_32x32x16_bf16 v[80:95], v[220:223], v[124:127], v[80:95]
  ds_read_b64_tr_b16 v[124:125], v7 offset:9216
  ds_read_b64_tr_b16 v[126:127], v7 offset:9728
  s_waitcnt lgkmcnt(15)
  v_mfma_f32_32x32x16_bf16 v[32:47], v[96:99], v[224:227], v[32:47]
  ds_read_b128 v[232:235], v4 offset:16384
  ds_read_b64_tr_b16 v[96:97], v6 offset:4096
  ds_read_b64_tr_b16 v[98:99], v6 offset:4608
  s_waitcnt lgkmcnt(15)
  v_mfma_f32_32x32x16_bf16 v[48:63], v[100:103], v[224:227], v[48:63]
  ds_read_b64_tr_b16 v[100:101], v7 offset:4096
  ds_read_b64_tr_b16 v[102:103], v7 offset:4608
  s_waitcnt lgkmcnt(15)
  v_mfma_f32_32x32x16_bf16 v[64:79], v[224:227], v[104:107], v[64:79]
  ds_read_b64_tr_b16 v[104:105], v6 offset:12288
  ds_read_b64_tr_b16 v[106:107], v6 offset:12800
  s_waitcnt lgkmcnt(15)
  v_mfma_f32_32x32x16_bf16 v[80:95], v[224:227], v[108:111], v[80:95]
  ds_read_b64_tr_b16 v[108:109], v7 offset:12288
  ds_read_b64_tr_b16 v[110:111], v7 offset:12800
  s_waitcnt lgkmcnt(15)
  v_mfma_f32_32x32x16_bf16 v[32:47], v[112:115], v[228:231], v[32:47]
  ds_read_b128 v[236:239], v5 offset:16384
  ds_read_b64_tr_b16 v[112:113], v6 offset:5120
  ds_read_b64_tr_b16 v[114:115], v6 offset:5632
  s_waitcnt lgkmcnt(15)
  v_mfma_f32_32x32x16_bf16 v[48:63], v[116:119], v[228:231], v[48:63]
  ds_read_b64_tr_b16 v[116:117], v7 offset:5120
  ds_read_b64_tr_b16 v[118:119], v7 offset:5632
  s_waitcnt lgkmcnt(15)
  v_mfma_f32_32x32x16_bf16 v[64:79], v[228:231], v[120:123], v[64:79]
  ds_read_b64_tr_b16 v[120:121], v6 offset:13312
  ds_read_b64_tr_b16 v[122:123], v6 offset:13824
  s_waitcnt lgkmcnt(15)
  v_mfma_f32_32x32x16_bf16 v[80:95], v[228:231], v[124:127], v[80:95]
  ds_read_b64_tr_b16 v[124:125], v7 offset:13312
  ds_read_b64_tr_b16 v[126:127], v7 offset:13824
  s_waitcnt lgkmcnt(15)
  v_mfma_f32_32x32x16_bf16 v[32:47], v[96:99], v[232:235], v[32:47]
  s_waitcnt lgkmcnt(13)
  v_mfma_f32_32x32x16_bf16 v[48:63], v[100:103], v[232:235], v[48:63]
  s_waitcnt lgkmcnt(0)
  s_barrier
  ds_read_b128 v[240:243], v2 offset:32768
  ds_read_b64_tr_b16 v[96:97], v6 offset:16384
  ds_read_b64_tr_b16 v[98:99], v6 offset:16896
  ds_read_b64_tr_b16 v[100:101], v7 offset:16384
  v_mfma_f32_32x32x16_bf16 v[64:79], v[232:235], v[104:107], v[64:79]
  ds_read_b64_tr_b16 v[102:103], v7 offset:16896
  ds_read_b64_tr_b16 v[104:105], v6 offset:24576
  ds_read_b64_tr_b16 v[106:107], v6 offset:25088
  v_mfma_f32_32x32x16_bf16 v[80:95], v[232:235], v[108:111], v[80:95]
  ds_read_b64_tr_b16 v[108:109], v7 offset:24576
  ds_read_b64_tr_b16 v[110:111], v7 offset:25088
  v_mfma_f32_32x32x16_bf16 v[32:47], v[112:115], v[236:239], v[32:47]
  ds_read_b128 v[244:247], v3 offset:32768
  ds_read_b64_tr_b16 v[112:113], v6 offset:17408
  ds_read_b64_tr_b16 v[114:115], v6 offset:17920
  v_mfma_f32_32x32x16_bf16 v[48:63], v[116:119], v[236:239], v[48:63]
  ds_read_b64_tr_b16 v[116:117], v7 offset:17408
  ds_read_b64_tr_b16 v[118:119], v7 offset:17920
  v_mfma_f32_32x32x16_bf16 v[64:79], v[236:239], v[120:123], v[64:79]
  ds_read_b64_tr_b16 v[120:121], v6 offset:25600
  ds_read_b64_tr_b16 v[122:123], v6 offset:26112
  v_mfma_f32_32x32x16_bf16 v[80:95], v[236:239], v[124:127], v[80:95]
  ds_read_b64_tr_b16 v[124:125], v7 offset:25600
  ds_read_b64_tr_b16 v[126:127], v7 offset:26112
  s_waitcnt lgkmcnt(15)
  v_mfma_f32_32x32x16_bf16 v[32:47], v[96:99], v[240:243], v[32:47]
  ds_read_b128 v[248:251], v4 offset:32768
  ds_read_b64_tr_b16 v[96:97], v6 offset:20480
  ds_read_b64_tr_b16 v[98:99], v6 offset:20992
  s_waitcnt lgkmcnt(15)
  v_mfma_f32_32x32x16_bf16 v[48:63], v[100:103], v[240:243], v[48:63]
  ds_read_b64_tr_b16 v[100:101], v7 offset:20480
  ds_read_b64_tr_b16 v[102:103], v7 offset:20992
  s_waitcnt lgkmcnt(15)
  v_mfma_f32_32x32x16_bf16 v[64:79], v[240:243], v[104:107], v[64:79]
  ds_read_b64_tr_b16 v[104:105], v6 offset:28672
  ds_read_b64_tr_b16 v[106:107], v6 offset:29184
  s_waitcnt lgkmcnt(15)
  v_mfma_f32_32x32x16_bf16 v[80:95], v[240:243], v[108:111], v[80:95]
  ds_read_b64_tr_b16 v[108:109], v7 offset:28672
  ds_read_b64_tr_b16 v[110:111], v7 offset:29184
  s_waitcnt lgkmcnt(15)
  v_mfma_f32_32x32x16_bf16 v[32:47], v[112:115], v[244:247], v[32:47]
  ds_read_b128 v[252:255], v5 offset:32768
  ds_read_b64_tr_b16 v[112:113], v6 offset:21504
  ds_read_b64_tr_b16 v[114:115], v6 offset:22016
  s_waitcnt lgkmcnt(15)
  v_mfma_f32_32x32x16_bf16 v[48:63], v[116:119], v[244:247], v[48:63]
  ds_read_b64_tr_b16 v[116:117], v7 offset:21504
  ds_read_b64_tr_b16 v[118:119], v7 offset:22016
  s_waitcnt lgkmcnt(15)
  v_mfma_f32_32x32x16_bf16 v[64:79], v[244:247], v[120:123], v[64:79]
  ds_read_b64_tr_b16 v[120:121], v6 offset:29696
  ds_read_b64_tr_b16 v[122:123], v6 offset:30208
  s_waitcnt lgkmcnt(15)
  v_mfma_f32_32x32x16_bf16 v[80:95], v[244:247], v[124:127], v[80:95]
  ds_read_b64_tr_b16 v[124:125], v7 offset:29696
  ds_read_b64_tr_b16 v[126:127], v7 offset:30208
  s_waitcnt lgkmcnt(15)
  v_mfma_f32_32x32x16_bf16 v[32:47], v[96:99], v[248:251], v[32:47]
  s_waitcnt lgkmcnt(13)
  v_mfma_f32_32x32x16_bf16 v[48:63], v[100:103], v[248:251], v[48:63]
  s_waitcnt lgkmcnt(0)
  s_barrier
  ds_read_b64_tr_b16 v[96:97], v28 offset:1024
  ds_read_b64_tr_b16 v[98:99], v28 offset:1280
  ds_read_b64_tr_b16 v[100:101], v28 offset:1536
  ds_read_b64_tr_b16 v[102:103], v28 offset:1792
  v_mfma_f32_32x32x16_bf16 v[64:79], v[248:251], v[104:107], v[64:79]
  ds_read_b64_tr_b16 v[104:105], v28 offset:0
  ds_read_b64_tr_b16 v[106:107], v28 offset:256
  v_mfma_f32_32x32x16_bf16 v[80:95], v[248:251], v[108:111], v[80:95]
  ds_read_b64_tr_b16 v[108:109], v28 offset:512
  ds_read_b64_tr_b16 v[110:111], v28 offset:768
  v_mfma_f32_32x32x16_bf16 v[32:47], v[112:115], v[252:255], v[32:47]
  v_mfma_f32_32x32x16_bf16 v[48:63], v[116:119], v[252:255], v[48:63]
  v_mfma_f32_32x32x16_bf16 v[64:79], v[252:255], v[120:123], v[64:79]
  s_waitcnt lgkmcnt(0)
  v_xor_b32 v96, v29, v96
  v_xor_b32 v97, v29, v97
  v_xor_b32_e64 v98, v29, v98
  v_mfma_f32_32x32x16_bf16 v[80:95], v[252:255], v[124:127], v[80:95]
  v_xor_b32 v99, v29, v99
  v_xor_b32 v100, v29, v100
  v_xor_b32 v101, v29, v101
  v_xor_b32 v102, v29, v102
  v_xor_b32 v103, v29, v103
  v_xor_b32 v104, v29, v104
  v_xor_b32 v105, v29, v105
  v_xor_b32 v106, v29, v106
  v_xor_b32 v107, v29, v107
  v_xor_b32 v108, v29, v108
  v_xor_b32 v109, v29, v109
  v_xor_b32 v110, v29, v110
  v_xor_b32 v111, v29, v111
  v_mov_b32 v2, v30
  v_xor_b32 v3, 16, v30
  v_xor_b32 v4, 32, v30
  v_xor_b32_e64 v5, 48, v30
  v_add_u32 v6, 90112, v6
  v_add_u32 v7, 90112, v7
  v_cvt_pk_bf16_f32 v112, v32, v33
  v_cvt_pk_bf16_f32 v113, v34, v35
  v_cvt_pk_bf16_f32 v114, v36, v37
  v_cvt_pk_bf16_f32 v115, v38, v39
  v_cvt_pk_bf16_f32 v116, v40, v41
  v_cvt_pk_bf16_f32 v117, v42, v43
  v_cvt_pk_bf16_f32 v118, v44, v45
  v_cvt_pk_bf16_f32 v119, v46, v47
  v_cvt_pk_bf16_f32 v120, v48, v49
  v_cvt_pk_bf16_f32 v121, v50, v51
  v_cvt_pk_bf16_f32 v122, v52, v53
  v_cvt_pk_bf16_f32 v123, v54, v55
  v_cvt_pk_bf16_f32 v124, v56, v57
  v_cvt_pk_bf16_f32 v125, v58, v59
  v_cvt_pk_bf16_f32 v126, v60, v61
  v_cvt_pk_bf16_f32 v127, v62, v63
  v_mfma_f32_32x32x16_bf16 v[32:47], v[104:107], v[112:115], 0
  v_mfma_f32_32x32x16_bf16 v[48:63], v[108:111], v[116:119], 0
  v_cvt_pk_bf16_f32 v64, v64, v65
  v_cvt_pk_bf16_f32 v65, v66, v67
  v_cvt_pk_bf16_f32 v66, v68, v69
  v_cvt_pk_bf16_f32 v67, v70, v71
  v_cvt_pk_bf16_f32 v68, v72, v73
  v_cvt_pk_bf16_f32 v69, v74, v75
  v_cvt_pk_bf16_f32 v70, v76, v77
  v_cvt_pk_bf16_f32 v71, v78, v79
  v_cvt_pk_bf16_f32 v80, v80, v81
  v_cvt_pk_bf16_f32 v81, v82, v83
  v_cvt_pk_bf16_f32 v82, v84, v85
  v_cvt_pk_bf16_f32 v83, v86, v87
  v_cvt_pk_bf16_f32 v84, v88, v89
  v_cvt_pk_bf16_f32 v85, v90, v91
  v_cvt_pk_bf16_f32 v86, v92, v93
  v_cvt_pk_bf16_f32 v87, v94, v95
  v_max3_f32 v28, v32, v33, v34
  v_max3_f32 v29, v35, v36, v37
  v_max3_f32 v29, v29, v38, v39
  v_max3_f32 v28, v28, v40, v41
  v_max3_f32 v29, v29, v42, v43
  v_max3_f32 v28, v28, v44, v45
  v_max3_f32 v29, v29, v46, v47
  v_max_f32 v28, v28, v29
  v_mul_f32 v28, s78, v28
  v_pk_fma_f32 v[32:33], v[32:33], s[78:79], v[28:29] op_sel_hi:[1,0,0] neg_lo:[0,0,1] neg_hi:[0,0,1]
  v_pk_fma_f32 v[34:35], v[34:35], s[78:79], v[28:29] op_sel_hi:[1,0,0] neg_lo:[0,0,1] neg_hi:[0,0,1]
  v_pk_fma_f32 v[36:37], v[36:37], s[78:79], v[28:29] op_sel_hi:[1,0,0] neg_lo:[0,0,1] neg_hi:[0,0,1]
  v_pk_fma_f32 v[38:39], v[38:39], s[78:79], v[28:29] op_sel_hi:[1,0,0] neg_lo:[0,0,1] neg_hi:[0,0,1]
  v_pk_fma_f32 v[40:41], v[40:41], s[78:79], v[28:29] op_sel_hi:[1,0,0] neg_lo:[0,0,1] neg_hi:[0,0,1]
  v_pk_fma_f32 v[42:43], v[42:43], s[78:79], v[28:29] op_sel_hi:[1,0,0] neg_lo:[0,0,1] neg_hi:[0,0,1]
  v_pk_fma_f32 v[44:45], v[44:45], s[78:79], v[28:29] op_sel_hi:[1,0,0] neg_lo:[0,0,1] neg_hi:[0,0,1]
  v_pk_fma_f32 v[46:47], v[46:47], s[78:79], v[28:29] op_sel_hi:[1,0,0] neg_lo:[0,0,1] neg_hi:[0,0,1]
  v_exp_f32 v32, v32
  v_exp_f32 v33, v33
  v_exp_f32 v34, v34
  v_exp_f32 v35, v35
  v_exp_f32 v36, v36
  v_exp_f32 v37, v37
  v_exp_f32 v38, v38
  v_exp_f32 v39, v39
  v_exp_f32 v40, v40
  v_exp_f32 v41, v41
  v_exp_f32 v42, v42
  v_exp_f32 v43, v43
  v_exp_f32 v44, v44
  v_exp_f32 v45, v45
  v_exp_f32 v46, v46
  v_exp_f32 v47, v47
  v_pk_add_f32 v[112:113], v[32:33], v[40:41]
  v_pk_add_f32 v[114:115], v[34:35], v[42:43]
  v_pk_add_f32 v[116:117], v[36:37], v[44:45]
  v_pk_add_f32 v[118:119], v[38:39], v[46:47]
  v_pk_add_f32 v[112:113], v[112:113], v[116:117]
  v_pk_add_f32 v[114:115], v[114:115], v[118:119]
  v_pk_add_f32 v[112:113], v[112:113], v[114:115]
  v_add_f32 v28, v112, v113
  v_rcp_f32_e64 v28, v28
  s_nop 0
  v_pk_mul_f32 v[32:33], v[32:33], v[28:29] op_sel_hi:[1,0]
  v_pk_mul_f32 v[34:35], v[34:35], v[28:29] op_sel_hi:[1,0]
  v_pk_mul_f32 v[36:37], v[36:37], v[28:29] op_sel_hi:[1,0]
  v_pk_mul_f32 v[38:39], v[38:39], v[28:29] op_sel_hi:[1,0]
  v_pk_mul_f32 v[40:41], v[40:41], v[28:29] op_sel_hi:[1,0]
  v_pk_mul_f32 v[42:43], v[42:43], v[28:29] op_sel_hi:[1,0]
  v_pk_mul_f32 v[44:45], v[44:45], v[28:29] op_sel_hi:[1,0]
  v_pk_mul_f32 v[46:47], v[46:47], v[28:29] op_sel_hi:[1,0]
  v_cvt_pk_bf16_f32 v112, v32, v33
  v_cvt_pk_bf16_f32 v113, v34, v35
  v_cvt_pk_bf16_f32 v114, v36, v37
  v_cvt_pk_bf16_f32 v115, v38, v39
  v_cvt_pk_bf16_f32 v116, v40, v41
  v_cvt_pk_bf16_f32 v117, v42, v43
  v_cvt_pk_bf16_f32 v118, v44, v45
  v_cvt_pk_bf16_f32 v119, v46, v47
  v_mfma_f32_32x32x16_bf16 v[32:47], v[112:115], v[8:11], 0
  v_cndmask_b32 v72, 0, v64, s[76:77]
  v_cndmask_b32 v73, 0, v65, s[76:77]
  v_cndmask_b32 v74, 0, v66, s[76:77]
  v_cndmask_b32 v75, 0, v67, s[76:77]
  v_cndmask_b32 v76, 0, v68, s[76:77]
  v_cndmask_b32 v77, 0, v69, s[76:77]
  v_mfma_f32_32x32x16_bf16 v[32:47], v[116:119], v[12:15], v[32:47]
  v_cndmask_b32 v78, 0, v70, s[76:77]
  v_cndmask_b32 v79, 0, v71, s[76:77]
  v_xor_b32 v64, v64, v72
  v_xor_b32 v65, v65, v73
  v_xor_b32 v66, v66, v74
  v_xor_b32 v67, v67, v75
  v_xor_b32 v68, v68, v76
  v_xor_b32 v69, v69, v77
  v_xor_b32 v70, v70, v78
  v_xor_b32 v71, v71, v79
  v_max3_f32 v28, v48, v49, v50
  v_max3_f32 v29, v51, v52, v53
  v_max3_f32 v29, v29, v54, v55
  v_max3_f32 v28, v28, v56, v57
  v_max3_f32 v29, v29, v58, v59
  v_max3_f32 v28, v28, v60, v61
  v_max3_f32 v29, v29, v62, v63
  v_max_f32 v28, v28, v29
  v_mul_f32 v28, s78, v28
  v_pk_fma_f32 v[48:49], v[48:49], s[78:79], v[28:29] op_sel_hi:[1,0,0] neg_lo:[0,0,1] neg_hi:[0,0,1]
  v_pk_fma_f32 v[50:51], v[50:51], s[78:79], v[28:29] op_sel_hi:[1,0,0] neg_lo:[0,0,1] neg_hi:[0,0,1]
  v_pk_fma_f32 v[52:53], v[52:53], s[78:79], v[28:29] op_sel_hi:[1,0,0] neg_lo:[0,0,1] neg_hi:[0,0,1]
  v_pk_fma_f32 v[54:55], v[54:55], s[78:79], v[28:29] op_sel_hi:[1,0,0] neg_lo:[0,0,1] neg_hi:[0,0,1]
  v_pk_fma_f32 v[56:57], v[56:57], s[78:79], v[28:29] op_sel_hi:[1,0,0] neg_lo:[0,0,1] neg_hi:[0,0,1]
  v_pk_fma_f32 v[58:59], v[58:59], s[78:79], v[28:29] op_sel_hi:[1,0,0] neg_lo:[0,0,1] neg_hi:[0,0,1]
  v_pk_fma_f32 v[60:61], v[60:61], s[78:79], v[28:29] op_sel_hi:[1,0,0] neg_lo:[0,0,1] neg_hi:[0,0,1]
  v_pk_fma_f32 v[62:63], v[62:63], s[78:79], v[28:29] op_sel_hi:[1,0,0] neg_lo:[0,0,1] neg_hi:[0,0,1]
  v_cvt_pk_bf16_f32 v112, v32, v33
  v_cvt_pk_bf16_f32 v113, v34, v35
  v_cvt_pk_bf16_f32 v114, v36, v37
  v_cvt_pk_bf16_f32 v115, v38, v39
  v_cvt_pk_bf16_f32 v116, v40, v41
  v_cvt_pk_bf16_f32 v117, v42, v43
  v_cvt_pk_bf16_f32 v118, v44, v45
  v_cvt_pk_bf16_f32 v119, v46, v47
  v_exp_f32 v48, v48
  v_exp_f32 v49, v49
  v_exp_f32_e64 v50, v50
  v_mfma_f32_32x32x16_bf16 v[32:47], v[112:115], v[64:67], 0
  v_exp_f32 v51, v51
  v_exp_f32 v52, v52
  v_exp_f32_e64 v53, v53
  v_mfma_f32_32x32x16_bf16 v[32:47], v[116:119], v[68:71], v[32:47]
  v_exp_f32 v54, v54
  v_exp_f32 v55, v55
  v_exp_f32_e64 v56, v56
  v_mfma_f32_16x16x32_bf16 v[20:23], v[16:19], v[112:115], 0
  v_mfma_f32_16x16x32_bf16 v[20:23], v[16:19], v[116:119], v[20:23]
  v_exp_f32 v57, v57
  v_exp_f32 v58, v58
  v_exp_f32 v59, v59
  v_exp_f32 v60, v60
  v_exp_f32 v61, v61
  v_exp_f32 v62, v62
  v_exp_f32_e64 v63, v63
  v_pk_add_f32 v[104:105], v[48:49], v[56:57]
  v_pk_add_f32 v[106:107], v[50:51], v[58:59]
  v_pk_add_f32 v[108:109], v[52:53], v[60:61]
  v_pk_add_f32 v[110:111], v[54:55], v[62:63]
  v_pk_add_f32 v[104:105], v[104:105], v[108:109]
  v_pk_add_f32 v[106:107], v[106:107], v[110:111]
  v_pk_add_f32 v[104:105], v[104:105], v[106:107]
  v_add_f32 v28, v104, v105
  v_rcp_f32_e64 v28, v28
  s_nop 0
  v_pk_mul_f32 v[48:49], v[48:49], v[28:29] op_sel_hi:[1,0]
  v_pk_mul_f32 v[50:51], v[50:51], v[28:29] op_sel_hi:[1,0]
  v_pk_mul_f32 v[52:53], v[52:53], v[28:29] op_sel_hi:[1,0]
  v_pk_mul_f32 v[54:55], v[54:55], v[28:29] op_sel_hi:[1,0]
  v_pk_mul_f32 v[56:57], v[56:57], v[28:29] op_sel_hi:[1,0]
  v_pk_mul_f32 v[58:59], v[58:59], v[28:29] op_sel_hi:[1,0]
  v_pk_mul_f32 v[60:61], v[60:61], v[28:29] op_sel_hi:[1,0]
  v_pk_mul_f32 v[62:63], v[62:63], v[28:29] op_sel_hi:[1,0]
  v_cvt_pk_bf16_f32 v104, v48, v49
  v_cvt_pk_bf16_f32 v105, v50, v51
  v_cvt_pk_bf16_f32 v106, v52, v53
  v_cvt_pk_bf16_f32 v107, v54, v55
  v_cvt_pk_bf16_f32 v108, v56, v57
  v_cvt_pk_bf16_f32 v109, v58, v59
  v_cvt_pk_bf16_f32 v110, v60, v61
  v_cvt_pk_bf16_f32 v111, v62, v63
  v_mfma_f32_32x32x16_bf16 v[48:63], v[104:107], v[8:11], 0
  v_cndmask_b32 v88, 0, v80, s[76:77]
  v_cndmask_b32 v89, 0, v81, s[76:77]
  v_cndmask_b32 v90, 0, v82, s[76:77]
  v_cndmask_b32 v91, 0, v83, s[76:77]
  v_mfma_f32_32x32x16_bf16 v[48:63], v[108:111], v[12:15], v[48:63]
  v_mfma_f32_32x32x16_bf16 v[104:119], v[96:99], v[120:123], 0
  v_cndmask_b32 v92, 0, v84, s[76:77]
  v_cndmask_b32 v93, 0, v85, s[76:77]
  v_cndmask_b32 v94, 0, v86, s[76:77]
  v_cndmask_b32 v95, 0, v87, s[76:77]
  v_xor_b32 v80, v80, v88
  v_xor_b32 v81, v81, v89
  v_xor_b32 v82, v82, v90
  v_xor_b32 v83, v83, v91
  v_xor_b32 v84, v84, v92
  v_xor_b32 v85, v85, v93
  v_xor_b32 v86, v86, v94
  v_xor_b32 v87, v87, v95
  v_max3_f32 v28, v104, v105, v106
  v_max3_f32 v29, v107, v108, v109
  v_max3_f32 v29, v29, v110, v111
  v_max3_f32 v28, v28, v112, v113
  v_max3_f32 v29, v29, v114, v115
  v_max3_f32 v28, v28, v116, v117
  v_max3_f32 v29, v29, v118, v119
  v_max_f32 v28, v28, v29
  v_mul_f32 v28, s78, v28
  v_pk_fma_f32 v[104:105], v[104:105], s[78:79], v[28:29] op_sel_hi:[1,0,0] neg_lo:[0,0,1] neg_hi:[0,0,1]
  v_pk_fma_f32 v[106:107], v[106:107], s[78:79], v[28:29] op_sel_hi:[1,0,0] neg_lo:[0,0,1] neg_hi:[0,0,1]
  v_pk_fma_f32 v[108:109], v[108:109], s[78:79], v[28:29] op_sel_hi:[1,0,0] neg_lo:[0,0,1] neg_hi:[0,0,1]
  v_pk_fma_f32 v[110:111], v[110:111], s[78:79], v[28:29] op_sel_hi:[1,0,0] neg_lo:[0,0,1] neg_hi:[0,0,1]
  v_pk_fma_f32 v[112:113], v[112:113], s[78:79], v[28:29] op_sel_hi:[1,0,0] neg_lo:[0,0,1] neg_hi:[0,0,1]
  v_pk_fma_f32 v[114:115], v[114:115], s[78:79], v[28:29] op_sel_hi:[1,0,0] neg_lo:[0,0,1] neg_hi:[0,0,1]
  v_pk_fma_f32 v[116:117], v[116:117], s[78:79], v[28:29] op_sel_hi:[1,0,0] neg_lo:[0,0,1] neg_hi:[0,0,1]
  v_pk_fma_f32 v[118:119], v[118:119], s[78:79], v[28:29] op_sel_hi:[1,0,0] neg_lo:[0,0,1] neg_hi:[0,0,1]
  v_cvt_pk_bf16_f32 v64, v48, v49
  v_cvt_pk_bf16_f32 v65, v50, v51
  v_cvt_pk_bf16_f32 v66, v52, v53
  v_cvt_pk_bf16_f32 v67, v54, v55
  v_cvt_pk_bf16_f32 v68, v56, v57
  v_cvt_pk_bf16_f32 v69, v58, v59
  v_cvt_pk_bf16_f32 v70, v60, v61
  v_cvt_pk_bf16_f32 v71, v62, v63
  v_exp_f32 v104, v104
  v_exp_f32 v105, v105
  v_mfma_f32_32x32x16_bf16 v[48:63], v[100:103], v[124:127], 0
  v_exp_f32 v106, v106
  v_exp_f32 v107, v107
  v_exp_f32_e64 v108, v108
  v_mfma_f32_32x32x16_bf16 v[32:47], v[64:67], v[72:75], v[32:47]
  v_exp_f32 v109, v109
  v_exp_f32 v110, v110
  v_mfma_f32_32x32x16_bf16 v[32:47], v[68:71], v[76:79], v[32:47]
  v_exp_f32 v111, v111
  v_exp_f32 v112, v112
  v_exp_f32_e64 v113, v113
  v_mfma_f32_16x16x32_bf16 v[24:27], v[16:19], v[64:67], 0
  v_mfma_f32_16x16x32_bf16 v[24:27], v[16:19], v[68:71], v[24:27]
  v_exp_f32 v114, v114
  v_exp_f32 v115, v115
  v_exp_f32 v116, v116
  v_exp_f32 v117, v117
  v_exp_f32 v118, v118
  v_exp_f32 v119, v119
  v_pk_add_f32 v[120:121], v[104:105], v[112:113]
  v_pk_add_f32 v[122:123], v[106:107], v[114:115]
  v_pk_add_f32 v[124:125], v[108:109], v[116:117]
  v_pk_add_f32 v[126:127], v[110:111], v[118:119]
  v_pk_add_f32 v[120:121], v[120:121], v[124:125]
  v_pk_add_f32 v[122:123], v[122:123], v[126:127]
  v_pk_add_f32 v[120:121], v[120:121], v[122:123]
  v_add_f32 v28, v120, v121
  v_rcp_f32_e64 v28, v28
  s_nop 0
  v_pk_mul_f32 v[104:105], v[104:105], v[28:29] op_sel_hi:[1,0]
  v_pk_mul_f32 v[106:107], v[106:107], v[28:29] op_sel_hi:[1,0]
  v_pk_mul_f32 v[108:109], v[108:109], v[28:29] op_sel_hi:[1,0]
  v_pk_mul_f32 v[110:111], v[110:111], v[28:29] op_sel_hi:[1,0]
  v_pk_mul_f32 v[112:113], v[112:113], v[28:29] op_sel_hi:[1,0]
  v_pk_mul_f32 v[114:115], v[114:115], v[28:29] op_sel_hi:[1,0]
  v_pk_mul_f32 v[116:117], v[116:117], v[28:29] op_sel_hi:[1,0]
  v_pk_mul_f32 v[118:119], v[118:119], v[28:29] op_sel_hi:[1,0]
  v_cvt_pk_bf16_f32 v120, v104, v105
  v_cvt_pk_bf16_f32 v121, v106, v107
  v_cvt_pk_bf16_f32 v122, v108, v109
  v_cvt_pk_bf16_f32 v123, v110, v111
  v_cvt_pk_bf16_f32 v124, v112, v113
  v_cvt_pk_bf16_f32 v125, v114, v115
  v_cvt_pk_bf16_f32 v126, v116, v117
  v_cvt_pk_bf16_f32 v127, v118, v119
  v_mfma_f32_32x32x16_bf16 v[104:119], v[120:123], v[8:11], 0
  s_mov_b32 exec_lo, 0
  v_mov_b32_e64 v20, v24
  s_mov_b32 exec_lo, -1
  ds_write_b32 v31, v20 offset:0
  ds_write_b128 v2, v[32:35] offset:0
  v_mfma_f32_32x32x16_bf16 v[104:119], v[124:127], v[12:15], v[104:119]
  v_max3_f32 v28, v48, v49, v50
  v_max3_f32 v29, v51, v52, v53
  v_max3_f32 v29, v29, v54, v55
  v_max3_f32 v28, v28, v56, v57
  v_max3_f32 v29, v29, v58, v59
  v_max3_f32 v28, v28, v60, v61
  v_max3_f32 v29, v29, v62, v63
  v_max_f32 v28, v28, v29
  v_mul_f32 v28, s78, v28
  v_pk_fma_f32 v[48:49], v[48:49], s[78:79], v[28:29] op_sel_hi:[1,0,0] neg_lo:[0,0,1] neg_hi:[0,0,1]
  v_pk_fma_f32 v[50:51], v[50:51], s[78:79], v[28:29] op_sel_hi:[1,0,0] neg_lo:[0,0,1] neg_hi:[0,0,1]
  v_pk_fma_f32 v[52:53], v[52:53], s[78:79], v[28:29] op_sel_hi:[1,0,0] neg_lo:[0,0,1] neg_hi:[0,0,1]
  v_pk_fma_f32 v[54:55], v[54:55], s[78:79], v[28:29] op_sel_hi:[1,0,0] neg_lo:[0,0,1] neg_hi:[0,0,1]
  v_pk_fma_f32 v[56:57], v[56:57], s[78:79], v[28:29] op_sel_hi:[1,0,0] neg_lo:[0,0,1] neg_hi:[0,0,1]
  v_pk_fma_f32 v[58:59], v[58:59], s[78:79], v[28:29] op_sel_hi:[1,0,0] neg_lo:[0,0,1] neg_hi:[0,0,1]
  v_pk_fma_f32 v[60:61], v[60:61], s[78:79], v[28:29] op_sel_hi:[1,0,0] neg_lo:[0,0,1] neg_hi:[0,0,1]
  v_pk_fma_f32 v[62:63], v[62:63], s[78:79], v[28:29] op_sel_hi:[1,0,0] neg_lo:[0,0,1] neg_hi:[0,0,1]
  v_cvt_pk_bf16_f32 v120, v104, v105
  v_cvt_pk_bf16_f32 v121, v106, v107
  v_cvt_pk_bf16_f32 v122, v108, v109
  v_cvt_pk_bf16_f32 v123, v110, v111
  v_cvt_pk_bf16_f32 v124, v112, v113
  v_cvt_pk_bf16_f32 v125, v114, v115
  v_cvt_pk_bf16_f32 v126, v116, v117
  ds_write_b128 v3, v[36:39] offset:0
  v_cvt_pk_bf16_f32 v127, v118, v119
  v_exp_f32 v48, v48
  v_exp_f32 v49, v49
  v_exp_f32_e64 v50, v50
  v_mfma_f32_32x32x16_bf16 v[64:79], v[120:123], v[80:83], 0
  v_exp_f32 v51, v51
  v_exp_f32 v52, v52
  v_exp_f32_e64 v53, v53
  v_mfma_f32_32x32x16_bf16 v[64:79], v[124:127], v[84:87], v[64:79]
  v_exp_f32 v54, v54
  v_exp_f32 v55, v55
  v_exp_f32_e64 v56, v56
  v_mfma_f32_16x16x32_bf16 v[20:23], v[16:19], v[120:123], 0
  v_mfma_f32_16x16x32_bf16 v[20:23], v[16:19], v[124:127], v[20:23]
  v_exp_f32 v57, v57
  v_exp_f32 v58, v58
  v_exp_f32 v59, v59
  v_exp_f32 v60, v60
  v_exp_f32 v61, v61
  v_exp_f32 v62, v62
  v_exp_f32_e64 v63, v63
  v_pk_add_f32 v[96:97], v[48:49], v[56:57]
  v_pk_add_f32 v[98:99], v[50:51], v[58:59]
  v_pk_add_f32 v[100:101], v[52:53], v[60:61]
  ds_write_b128 v4, v[40:43] offset:0
  v_pk_add_f32 v[102:103], v[54:55], v[62:63]
  v_pk_add_f32 v[96:97], v[96:97], v[100:101]
  v_pk_add_f32 v[98:99], v[98:99], v[102:103]
  v_pk_add_f32 v[96:97], v[96:97], v[98:99]
  v_add_f32 v28, v96, v97
  v_rcp_f32_e64 v28, v28
  s_nop 0
  v_pk_mul_f32 v[48:49], v[48:49], v[28:29] op_sel_hi:[1,0]
  v_pk_mul_f32 v[50:51], v[50:51], v[28:29] op_sel_hi:[1,0]
  v_pk_mul_f32 v[52:53], v[52:53], v[28:29] op_sel_hi:[1,0]
  v_pk_mul_f32 v[54:55], v[54:55], v[28:29] op_sel_hi:[1,0]
  v_pk_mul_f32 v[56:57], v[56:57], v[28:29] op_sel_hi:[1,0]
  v_pk_mul_f32 v[58:59], v[58:59], v[28:29] op_sel_hi:[1,0]
  v_pk_mul_f32 v[60:61], v[60:61], v[28:29] op_sel_hi:[1,0]
  v_pk_mul_f32 v[62:63], v[62:63], v[28:29] op_sel_hi:[1,0]
  v_cvt_pk_bf16_f32 v96, v48, v49
  v_cvt_pk_bf16_f32 v97, v50, v51
  v_cvt_pk_bf16_f32 v98, v52, v53
  v_cvt_pk_bf16_f32 v99, v54, v55
  v_cvt_pk_bf16_f32 v100, v56, v57
  v_cvt_pk_bf16_f32 v101, v58, v59
  v_cvt_pk_bf16_f32 v102, v60, v61
  v_cvt_pk_bf16_f32 v103, v62, v63
  ds_write_b128 v5, v[44:47] offset:0
  v_mfma_f32_32x32x16_bf16 v[48:63], v[96:99], v[8:11], 0
  s_nop 0
  v_mfma_f32_32x32x16_bf16 v[48:63], v[100:103], v[12:15], v[48:63]
  s_nop 11
  v_cvt_pk_bf16_f32 v96, v48, v49
  v_cvt_pk_bf16_f32 v97, v50, v51
  v_cvt_pk_bf16_f32 v98, v52, v53
  v_cvt_pk_bf16_f32 v99, v54, v55
  v_cvt_pk_bf16_f32 v100, v56, v57
  v_cvt_pk_bf16_f32 v101, v58, v59
  v_cvt_pk_bf16_f32 v102, v60, v61
  v_cvt_pk_bf16_f32 v103, v62, v63
  v_mfma_f32_32x32x16_bf16 v[64:79], v[96:99], v[88:91], v[64:79]
  s_nop 0
  v_mfma_f32_32x32x16_bf16 v[64:79], v[100:103], v[92:95], v[64:79]
  v_mfma_f32_16x16x32_bf16 v[24:27], v[16:19], v[96:99], 0
  v_mfma_f32_16x16x32_bf16 v[24:27], v[16:19], v[100:103], v[24:27]
  s_nop 9
  ds_write_b128 v2, v[64:67] offset:4096
  ds_write_b128 v3, v[68:71] offset:4096
  ds_write_b128 v4, v[72:75] offset:4096
  ds_write_b128 v5, v[76:79] offset:4096
  s_mov_b32 exec_lo, 0
  v_mov_b32_e64 v20, v24
  s_mov_b32 exec_lo, -1
  ds_write_b32 v31, v20 offset:256
  s_waitcnt lgkmcnt(0)
  s_barrier
  ds_read_b64_tr_b16 v[96:97], v6 offset:16384
  ds_read_b64_tr_b16 v[98:99], v6 offset:16896
  ds_read_b64_tr_b16 v[100:101], v7 offset:16384
  ds_read_b64_tr_b16 v[102:103], v7 offset:16896
  ds_read_b64_tr_b16 v[104:105], v6 offset:17408
  ds_read_b64_tr_b16 v[106:107], v6 offset:17920
  ds_read_b64_tr_b16 v[108:109], v7 offset:17408
  ds_read_b64_tr_b16 v[110:111], v7 offset:17920
  ds_read_b64_tr_b16 v[112:113], v6 offset:20480
  ds_read_b64_tr_b16 v[114:115], v6 offset:20992
  ds_read_b64_tr_b16 v[116:117], v7 offset:20480
  ds_read_b64_tr_b16 v[118:119], v7 offset:20992
  s_waitcnt lgkmcnt(10)
  v_mfma_f32_32x32x16_bf16 v[32:47], v[96:99], v[128:131], 0
  ds_read_b64_tr_b16 v[120:121], v6 offset:21504
  ds_read_b64_tr_b16 v[122:123], v6 offset:22016
  s_waitcnt lgkmcnt(10)
  v_mfma_f32_32x32x16_bf16 v[48:63], v[100:103], v[128:131], 0
  ds_read_b64_tr_b16 v[124:125], v7 offset:21504
  ds_read_b64_tr_b16 v[126:127], v7 offset:22016
  s_waitcnt lgkmcnt(10)
  v_mfma_f32_32x32x16_bf16 v[32:47], v[104:107], v[132:135], v[32:47]
  ds_read_b64_tr_b16 v[96:97], v6 offset:24576
  ds_read_b64_tr_b16 v[98:99], v6 offset:25088
  s_waitcnt lgkmcnt(10)
  v_mfma_f32_32x32x16_bf16 v[48:63], v[108:111], v[132:135], v[48:63]
  ds_read_b64_tr_b16 v[100:101], v7 offset:24576
  ds_read_b64_tr_b16 v[102:103], v7 offset:25088
  s_waitcnt lgkmcnt(10)
  v_mfma_f32_32x32x16_bf16 v[32:47], v[112:115], v[136:139], v[32:47]
  ds_read_b64_tr_b16 v[104:105], v6 offset:25600
  ds_read_b64_tr_b16 v[106:107], v6 offset:26112
  s_waitcnt lgkmcnt(10)
  v_mfma_f32_32x32x16_bf16 v[48:63], v[116:119], v[136:139], v[48:63]
  ds_read_b64_tr_b16 v[108:109], v7 offset:25600
  ds_read_b64_tr_b16 v[110:111], v7 offset:26112
  s_waitcnt lgkmcnt(10)
  v_mfma_f32_32x32x16_bf16 v[32:47], v[120:123], v[140:143], v[32:47]
  ds_read_b64_tr_b16 v[112:113], v6 offset:28672
  ds_read_b64_tr_b16 v[114:115], v6 offset:29184
  s_waitcnt lgkmcnt(10)
  v_mfma_f32_32x32x16_bf16 v[48:63], v[124:127], v[140:143], v[48:63]
  ds_read_b64_tr_b16 v[116:117], v7 offset:28672
  ds_read_b64_tr_b16 v[118:119], v7 offset:29184
  s_waitcnt lgkmcnt(10)
  v_mfma_f32_32x32x16_bf16 v[32:47], v[96:99], v[144:147], v[32:47]
  ds_read_b64_tr_b16 v[120:121], v6 offset:29696
  ds_read_b64_tr_b16 v[122:123], v6 offset:30208
  v_bfe_u32 v28, v0, 2, 2
  s_waitcnt lgkmcnt(10)
  v_mfma_f32_32x32x16_bf16 v[48:63], v[100:103], v[144:147], v[48:63]
  ds_read_b64_tr_b16 v[124:125], v7 offset:29696
  ds_read_b64_tr_b16 v[126:127], v7 offset:30208
  v_lshlrev_b32 v28, 5, v28
  s_waitcnt lgkmcnt(10)
  v_mfma_f32_32x32x16_bf16 v[32:47], v[104:107], v[148:151], v[32:47]
  ds_read_b64_tr_b16 v[96:97], v6 offset:32768
  ds_read_b64_tr_b16 v[98:99], v6 offset:33280
  v_bfe_u32 v29, v0, 4, 1
  s_waitcnt lgkmcnt(10)
  v_mfma_f32_32x32x16_bf16 v[48:63], v[108:111], v[148:151], v[48:63]
  ds_read_b64_tr_b16 v[100:101], v7 offset:32768
  ds_read_b64_tr_b16 v[102:103], v7 offset:33280
  v_lshl_add_u32 v28, v29, 4, v28
  s_waitcnt lgkmcnt(10)
  v_mfma_f32_32x32x16_bf16 v[32:47], v[112:115], v[152:155], v[32:47]
  ds_read_b64_tr_b16 v[104:105], v6 offset:33792
  ds_read_b64_tr_b16 v[106:107], v6 offset:34304
  v_bfe_u32 v29, v0, 1, 1
  s_waitcnt lgkmcnt(10)
  v_mfma_f32_32x32x16_bf16 v[48:63], v[116:119], v[152:155], v[48:63]
  ds_read_b64_tr_b16 v[108:109], v7 offset:33792
  ds_read_b64_tr_b16 v[110:111], v7 offset:34304
  v_lshl_add_u32 v28, v29, 3, v28
  s_waitcnt lgkmcnt(10)
  v_mfma_f32_32x32x16_bf16 v[32:47], v[120:123], v[156:159], v[32:47]
  ds_read_b64_tr_b16 v[112:113], v6 offset:36864
  ds_read_b64_tr_b16 v[114:115], v6 offset:37376
  v_lshrrev_b32 v29, 5, v0
  s_waitcnt lgkmcnt(10)
  v_mfma_f32_32x32x16_bf16 v[48:63], v[124:127], v[156:159], v[48:63]
  ds_read_b64_tr_b16 v[116:117], v7 offset:36864
  ds_read_b64_tr_b16 v[118:119], v7 offset:37376
  v_lshl_add_u32 v28, v29, 7, v28
  s_waitcnt lgkmcnt(10)
  v_mfma_f32_32x32x16_bf16 v[32:47], v[96:99], v[160:163], v[32:47]
  ds_read_b64_tr_b16 v[120:121], v6 offset:37888
  ds_read_b64_tr_b16 v[122:123], v6 offset:38400
  v_add_u32 v28, 155648, v28
  s_waitcnt lgkmcnt(10)
  v_mfma_f32_32x32x16_bf16 v[48:63], v[100:103], v[160:163], v[48:63]
  ds_read_b64_tr_b16 v[124:125], v7 offset:37888
  ds_read_b64_tr_b16 v[126:127], v7 offset:38400
  v_bfe_u32 v29, v0, 2, 1
  s_waitcnt lgkmcnt(10)
  v_mfma_f32_32x32x16_bf16 v[32:47], v[104:107], v[164:167], v[32:47]
  ds_read_b64_tr_b16 v[96:97], v6 offset:40960
  ds_read_b64_tr_b16 v[98:99], v6 offset:41472
  v_mul_u32_u24 v29, 0x8000, v29
  s_waitcnt lgkmcnt(10)
  v_mfma_f32_32x32x16_bf16 v[48:63], v[108:111], v[164:167], v[48:63]
  ds_read_b64_tr_b16 v[100:101], v7 offset:40960
  ds_read_b64_tr_b16 v[102:103], v7 offset:41472
  v_lshl_add_u32 v29, v29, 16, v29
  s_waitcnt lgkmcnt(10)
  v_mfma_f32_32x32x16_bf16 v[32:47], v[112:115], v[168:171], v[32:47]
  ds_read_b64_tr_b16 v[104:105], v6 offset:41984
  ds_read_b64_tr_b16 v[106:107], v6 offset:42496
  ds_read_b64_tr_b16 v[128:129], v28 offset:0
  s_waitcnt lgkmcnt(11)
  v_mfma_f32_32x32x16_bf16 v[48:63], v[116:119], v[168:171], v[48:63]
  ds_read_b64_tr_b16 v[108:109], v7 offset:41984
  ds_read_b64_tr_b16 v[110:111], v7 offset:42496
  ds_read_b64_tr_b16 v[130:131], v28 offset:256
  s_waitcnt lgkmcnt(12)
  v_mfma_f32_32x32x16_bf16 v[32:47], v[120:123], v[172:175], v[32:47]
  ds_read_b64_tr_b16 v[112:113], v6 offset:45056
  ds_read_b64_tr_b16 v[114:115], v6 offset:45568
  ds_read_b64_tr_b16 v[132:133], v28 offset:512
  s_waitcnt lgkmcnt(13)
  v_mfma_f32_32x32x16_bf16 v[48:63], v[124:127], v[172:175], v[48:63]
  ds_read_b64_tr_b16 v[116:117], v7 offset:45056
  ds_read_b64_tr_b16 v[118:119], v7 offset:45568
  ds_read_b64_tr_b16 v[134:135], v28 offset:768
  s_waitcnt lgkmcnt(14)
  v_mfma_f32_32x32x16_bf16 v[32:47], v[96:99], v[176:179], v[32:47]
  ds_read_b64_tr_b16 v[120:121], v6 offset:46080
  ds_read_b64_tr_b16 v[122:123], v6 offset:46592
  ds_read_b64_tr_b16 v[136:137], v28 offset:1024
  s_waitcnt lgkmcnt(15)
  v_mfma_f32_32x32x16_bf16 v[48:63], v[100:103], v[176:179], v[48:63]
  ds_read_b64_tr_b16 v[124:125], v7 offset:46080
  ds_read_b64_tr_b16 v[126:127], v7 offset:46592
  ds_read_b64_tr_b16 v[138:139], v28 offset:1280
  s_waitcnt lgkmcnt(15)
  v_mfma_f32_32x32x16_bf16 v[32:47], v[104:107], v[180:183], v[32:47]
  ds_read_b64_tr_b16 v[96:97], v6 offset:49152
  ds_read_b64_tr_b16 v[98:99], v6 offset:49664
  ds_read_b64_tr_b16 v[140:141], v28 offset:1536
  s_waitcnt lgkmcnt(15)
  v_mfma_f32_32x32x16_bf16 v[48:63], v[108:111], v[180:183], v[48:63]
  ds_read_b64_tr_b16 v[100:101], v7 offset:49152
  ds_read_b64_tr_b16 v[102:103], v7 offset:49664
  ds_read_b64_tr_b16 v[142:143], v28 offset:1792
  s_waitcnt lgkmcnt(15)
  v_mfma_f32_32x32x16_bf16 v[32:47], v[112:115], v[184:187], v[32:47]
  ds_read_b64_tr_b16 v[104:105], v6 offset:50176
  ds_read_b64_tr_b16 v[106:107], v6 offset:50688
  v_lshrrev_b32_e64 v30, 5, v0
  s_waitcnt lgkmcnt(15)
  v_mfma_f32_32x32x16_bf16 v[48:63], v[116:119], v[184:187], v[48:63]
  ds_read_b64_tr_b16 v[108:109], v7 offset:50176
  ds_read_b64_tr_b16 v[110:111], v7 offset:50688
  v_lshlrev_b32 v30, 1, v30
  s_waitcnt lgkmcnt(14)
  v_mfma_f32_32x32x16_bf16 v[32:47], v[120:123], v[188:191], v[32:47]
  ds_read_b64_tr_b16 v[112:113], v6 offset:53248
  ds_read_b64_tr_b16 v[114:115], v6 offset:53760
  v_bfe_u32 v31, v0, 2, 2
  s_waitcnt lgkmcnt(13)
  v_mfma_f32_32x32x16_bf16 v[48:63], v[124:127], v[188:191], v[48:63]
  ds_read_b64_tr_b16 v[116:117], v7 offset:53248
  ds_read_b64_tr_b16 v[118:119], v7 offset:53760
  v_xor_b32_e64 v30, v30, v31
  s_waitcnt lgkmcnt(12)
  v_mfma_f32_32x32x16_bf16 v[32:47], v[96:99], v[192:195], v[32:47]
  ds_read_b64_tr_b16 v[120:121], v6 offset:54272
  ds_read_b64_tr_b16 v[122:123], v6 offset:54784
  v_lshlrev_b32 v30, 4, v30
  s_waitcnt lgkmcnt(11)
  v_mfma_f32_32x32x16_bf16 v[48:63], v[100:103], v[192:195], v[48:63]
  ds_read_b64_tr_b16 v[124:125], v7 offset:54272
  ds_read_b64_tr_b16 v[126:127], v7 offset:54784
  v_and_b32 v31, 31, v0
  s_waitcnt lgkmcnt(10)
  v_mfma_f32_32x32x16_bf16 v[32:47], v[104:107], v[196:199], v[32:47]
  ds_read_b64_tr_b16 v[96:97], v6 offset:57344
  ds_read_b64_tr_b16 v[98:99], v6 offset:57856
  v_lshl_add_u32 v30, v31, 6, v30
  s_waitcnt lgkmcnt(10)
  v_mfma_f32_32x32x16_bf16 v[48:63], v[108:111], v[196:199], v[48:63]
  ds_read_b64_tr_b16 v[100:101], v7 offset:57344
  ds_read_b64_tr_b16 v[102:103], v7 offset:57856
  v_add_u32 v30, 81920, v30
  s_waitcnt lgkmcnt(10)
  v_mfma_f32_32x32x16_bf16 v[32:47], v[112:115], v[200:203], v[32:47]
  ds_read_b64_tr_b16 v[104:105], v6 offset:58368
  ds_read_b64_tr_b16 v[106:107], v6 offset:58880
  v_xor_b32 v31, 16, v30
  s_waitcnt lgkmcnt(10)
  v_mfma_f32_32x32x16_bf16 v[48:63], v[116:119], v[200:203], v[48:63]
  ds_read_b64_tr_b16 v[108:109], v7 offset:58368
  ds_read_b64_tr_b16 v[110:111], v7 offset:58880
  s_waitcnt lgkmcnt(10)
  v_mfma_f32_32x32x16_bf16 v[32:47], v[120:123], v[204:207], v[32:47]
  ds_read_b64_tr_b16 v[112:113], v6 offset:61440
  ds_read_b64_tr_b16 v[114:115], v6 offset:61952
  v_xor_b32_e64 v128, v29, v128
  s_waitcnt lgkmcnt(10)
  v_mfma_f32_32x32x16_bf16 v[48:63], v[124:127], v[204:207], v[48:63]
  ds_read_b64_tr_b16 v[116:117], v7 offset:61440
  ds_read_b64_tr_b16 v[118:119], v7 offset:61952
  v_xor_b32 v129, v29, v129
  s_waitcnt lgkmcnt(10)
  v_mfma_f32_32x32x16_bf16 v[32:47], v[96:99], v[208:211], v[32:47]
  ds_read_b64_tr_b16 v[120:121], v6 offset:62464
  ds_read_b64_tr_b16 v[122:123], v6 offset:62976
  v_xor_b32 v130, v29, v130
  s_waitcnt lgkmcnt(10)
  v_mfma_f32_32x32x16_bf16 v[48:63], v[100:103], v[208:211], v[48:63]
  ds_read_b64_tr_b16 v[124:125], v7 offset:62464
  ds_read_b64_tr_b16 v[126:127], v7 offset:62976
  v_xor_b32 v131, v29, v131
  s_waitcnt lgkmcnt(10)
  v_mfma_f32_32x32x16_bf16 v[32:47], v[104:107], v[212:215], v[32:47]
  ds_read_b64_tr_b16 v[96:97], v6 offset:0
  ds_read_b64_tr_b16 v[98:99], v6 offset:512
  v_xor_b32 v132, v29, v132
  s_waitcnt lgkmcnt(10)
  v_mfma_f32_32x32x16_bf16 v[48:63], v[108:111], v[212:215], v[48:63]
  ds_read_b64_tr_b16 v[100:101], v7 offset:0
  ds_read_b64_tr_b16 v[102:103], v7 offset:512
  v_xor_b32 v133, v29, v133
  s_waitcnt lgkmcnt(10)
  v_mfma_f32_32x32x16_bf16 v[32:47], v[112:115], v[216:219], v[32:47]
  ds_read_b64_tr_b16 v[104:105], v6 offset:1024
  ds_read_b64_tr_b16 v[106:107], v6 offset:1536
  v_xor_b32 v134, v29, v134
  s_waitcnt lgkmcnt(10)
  v_mfma_f32_32x32x16_bf16 v[48:63], v[116:119], v[216:219], v[48:63]
  ds_read_b64_tr_b16 v[108:109], v7 offset:1024
  ds_read_b64_tr_b16 v[110:111], v7 offset:1536
  v_xor_b32 v135, v29, v135
  s_waitcnt lgkmcnt(10)
  v_mfma_f32_32x32x16_bf16 v[32:47], v[120:123], v[220:223], v[32:47]
  ds_read_b64_tr_b16 v[112:113], v6 offset:4096
  ds_read_b64_tr_b16 v[114:115], v6 offset:4608
  v_xor_b32 v136, v29, v136
  s_waitcnt lgkmcnt(10)
  v_mfma_f32_32x32x16_bf16 v[48:63], v[124:127], v[220:223], v[48:63]
  ds_read_b64_tr_b16 v[116:117], v7 offset:4096
  ds_read_b64_tr_b16 v[118:119], v7 offset:4608
  v_xor_b32 v137, v29, v137
  s_waitcnt lgkmcnt(10)
  v_mfma_f32_32x32x16_bf16 v[32:47], v[96:99], v[224:227], v[32:47]
  ds_read_b64_tr_b16 v[120:121], v6 offset:5120
  ds_read_b64_tr_b16 v[122:123], v6 offset:5632
  v_xor_b32 v138, v29, v138
  s_waitcnt lgkmcnt(10)
  v_mfma_f32_32x32x16_bf16 v[48:63], v[100:103], v[224:227], v[48:63]
  ds_read_b64_tr_b16 v[124:125], v7 offset:5120
  ds_read_b64_tr_b16 v[126:127], v7 offset:5632
  v_xor_b32 v139, v29, v139
  s_waitcnt lgkmcnt(10)
  v_mfma_f32_32x32x16_bf16 v[32:47], v[104:107], v[228:231], v[32:47]
  ds_read_b64_tr_b16 v[96:97], v6 offset:8192
  ds_read_b64_tr_b16 v[98:99], v6 offset:8704
  v_xor_b32 v140, v29, v140
  s_waitcnt lgkmcnt(10)
  v_mfma_f32_32x32x16_bf16 v[48:63], v[108:111], v[228:231], v[48:63]
  ds_read_b64_tr_b16 v[100:101], v7 offset:8192
  ds_read_b64_tr_b16 v[102:103], v7 offset:8704
  v_xor_b32 v141, v29, v141
  s_waitcnt lgkmcnt(10)
  v_mfma_f32_32x32x16_bf16 v[32:47], v[112:115], v[232:235], v[32:47]
  ds_read_b64_tr_b16 v[104:105], v6 offset:9216
  ds_read_b64_tr_b16 v[106:107], v6 offset:9728
  v_xor_b32 v142, v29, v142
  s_waitcnt lgkmcnt(10)
  v_mfma_f32_32x32x16_bf16 v[48:63], v[116:119], v[232:235], v[48:63]
  ds_read_b64_tr_b16 v[108:109], v7 offset:9216
  ds_read_b64_tr_b16 v[110:111], v7 offset:9728
  v_xor_b32 v143, v29, v143
  s_waitcnt lgkmcnt(10)
  v_mfma_f32_32x32x16_bf16 v[32:47], v[120:123], v[236:239], v[32:47]
  ds_read_b64_tr_b16 v[112:113], v6 offset:12288
  ds_read_b64_tr_b16 v[114:115], v6 offset:12800
  s_waitcnt lgkmcnt(10)
  v_mfma_f32_32x32x16_bf16 v[48:63], v[124:127], v[236:239], v[48:63]
  ds_read_b64_tr_b16 v[116:117], v7 offset:12288
  ds_read_b64_tr_b16 v[118:119], v7 offset:12800
  s_waitcnt lgkmcnt(10)
  v_mfma_f32_32x32x16_bf16 v[32:47], v[96:99], v[240:243], v[32:47]
  ds_read_b64_tr_b16 v[120:121], v6 offset:13312
  ds_read_b64_tr_b16 v[122:123], v6 offset:13824
  s_waitcnt lgkmcnt(10)
  v_mfma_f32_32x32x16_bf16 v[48:63], v[100:103], v[240:243], v[48:63]
  ds_read_b64_tr_b16 v[124:125], v7 offset:13312
  ds_read_b64_tr_b16 v[126:127], v7 offset:13824
  s_waitcnt lgkmcnt(10)
  v_mfma_f32_32x32x16_bf16 v[32:47], v[104:107], v[244:247], v[32:47]
  s_waitcnt lgkmcnt(8)
  v_mfma_f32_32x32x16_bf16 v[48:63], v[108:111], v[244:247], v[48:63]
  s_waitcnt lgkmcnt(6)
  v_mfma_f32_32x32x16_bf16 v[32:47], v[112:115], v[248:251], v[32:47]
  s_waitcnt lgkmcnt(4)
  v_mfma_f32_32x32x16_bf16 v[48:63], v[116:119], v[248:251], v[48:63]
  s_waitcnt lgkmcnt(2)
  v_mfma_f32_32x32x16_bf16 v[32:47], v[120:123], v[252:255], v[32:47]
  s_waitcnt lgkmcnt(0)
  v_mfma_f32_32x32x16_bf16 v[48:63], v[124:127], v[252:255], v[48:63]
  s_nop 10
  v_cvt_pk_bf16_f32 v144, v32, v33
  v_cvt_pk_bf16_f32 v145, v34, v35
  v_cvt_pk_bf16_f32 v146, v36, v37
  v_cvt_pk_bf16_f32 v147, v38, v39
  v_cvt_pk_bf16_f32 v148, v40, v41
  v_cvt_pk_bf16_f32 v149, v42, v43
  v_cvt_pk_bf16_f32 v150, v44, v45
  v_cvt_pk_bf16_f32 v151, v46, v47
  v_mfma_f32_32x32x16_bf16 v[160:175], v[128:131], v[144:147], 0
  s_nop 0
  v_mfma_f32_32x32x16_bf16 v[176:191], v[132:135], v[148:151], 0
  v_cvt_pk_bf16_f32 v152, v48, v49
  v_cvt_pk_bf16_f32 v153, v50, v51
  v_cvt_pk_bf16_f32 v154, v52, v53
  v_cvt_pk_bf16_f32 v155, v54, v55
  v_cvt_pk_bf16_f32 v156, v56, v57
  v_cvt_pk_bf16_f32 v157, v58, v59
  v_cvt_pk_bf16_f32 v158, v60, v61
  v_cvt_pk_bf16_f32 v159, v62, v63
  s_nop 1
  v_max3_f32 v28, v160, v161, v162
  v_max3_f32 v29, v163, v164, v165
  v_max3_f32 v29, v29, v166, v167
  v_max3_f32 v28, v28, v168, v169
  v_max3_f32 v29, v29, v170, v171
  v_max3_f32 v28, v28, v172, v173
  v_max3_f32 v29, v29, v174, v175
  v_max_f32 v28, v28, v29
  v_mul_f32 v28, s78, v28
  v_pk_fma_f32 v[160:161], v[160:161], s[78:79], v[28:29] op_sel_hi:[1,0,0] neg_lo:[0,0,1] neg_hi:[0,0,1]
  v_pk_fma_f32 v[162:163], v[162:163], s[78:79], v[28:29] op_sel_hi:[1,0,0] neg_lo:[0,0,1] neg_hi:[0,0,1]
  v_pk_fma_f32 v[164:165], v[164:165], s[78:79], v[28:29] op_sel_hi:[1,0,0] neg_lo:[0,0,1] neg_hi:[0,0,1]
  v_pk_fma_f32 v[166:167], v[166:167], s[78:79], v[28:29] op_sel_hi:[1,0,0] neg_lo:[0,0,1] neg_hi:[0,0,1]
  v_pk_fma_f32 v[168:169], v[168:169], s[78:79], v[28:29] op_sel_hi:[1,0,0] neg_lo:[0,0,1] neg_hi:[0,0,1]
  v_pk_fma_f32 v[170:171], v[170:171], s[78:79], v[28:29] op_sel_hi:[1,0,0] neg_lo:[0,0,1] neg_hi:[0,0,1]
  v_pk_fma_f32 v[172:173], v[172:173], s[78:79], v[28:29] op_sel_hi:[1,0,0] neg_lo:[0,0,1] neg_hi:[0,0,1]
  v_pk_fma_f32 v[174:175], v[174:175], s[78:79], v[28:29] op_sel_hi:[1,0,0] neg_lo:[0,0,1] neg_hi:[0,0,1]
  v_mfma_f32_32x32x16_bf16 v[192:207], v[136:139], v[152:155], 0
  v_exp_f32 v160, v160
  v_exp_f32 v161, v161
  v_exp_f32 v162, v162
  v_exp_f32 v163, v163
  v_exp_f32 v164, v164
  v_exp_f32 v165, v165
  v_mfma_f32_32x32x16_bf16 v[208:223], v[140:143], v[156:159], 0
  v_exp_f32 v166, v166
  v_exp_f32 v167, v167
  v_exp_f32 v168, v168
  v_exp_f32 v169, v169
  v_exp_f32 v170, v170
  v_exp_f32 v171, v171
  v_exp_f32 v172, v172
  v_exp_f32 v173, v173
  v_exp_f32 v174, v174
  v_exp_f32 v175, v175
  v_pk_add_f32 v[64:65], v[160:161], v[168:169]
  v_pk_add_f32 v[66:67], v[162:163], v[170:171]
  v_pk_add_f32 v[68:69], v[164:165], v[172:173]
  v_pk_add_f32 v[70:71], v[166:167], v[174:175]
  v_pk_add_f32 v[64:65], v[64:65], v[68:69]
  v_pk_add_f32 v[66:67], v[66:67], v[70:71]
  v_pk_add_f32 v[64:65], v[64:65], v[66:67]
  v_add_f32 v28, v64, v65
  v_rcp_f32_e64 v28, v28
  s_nop 0
  v_pk_mul_f32 v[160:161], v[160:161], v[28:29] op_sel_hi:[1,0]
  v_pk_mul_f32 v[162:163], v[162:163], v[28:29] op_sel_hi:[1,0]
  v_pk_mul_f32 v[164:165], v[164:165], v[28:29] op_sel_hi:[1,0]
  v_pk_mul_f32 v[166:167], v[166:167], v[28:29] op_sel_hi:[1,0]
  v_pk_mul_f32 v[168:169], v[168:169], v[28:29] op_sel_hi:[1,0]
  v_pk_mul_f32 v[170:171], v[170:171], v[28:29] op_sel_hi:[1,0]
  v_pk_mul_f32 v[172:173], v[172:173], v[28:29] op_sel_hi:[1,0]
  v_pk_mul_f32 v[174:175], v[174:175], v[28:29] op_sel_hi:[1,0]
  v_cvt_pk_bf16_f32 v64, v160, v161
  v_cvt_pk_bf16_f32 v65, v162, v163
  v_cvt_pk_bf16_f32 v66, v164, v165
  v_cvt_pk_bf16_f32 v67, v166, v167
  v_cvt_pk_bf16_f32 v68, v168, v169
  v_cvt_pk_bf16_f32 v69, v170, v171
  v_cvt_pk_bf16_f32 v70, v172, v173
  v_cvt_pk_bf16_f32 v71, v174, v175
  v_max3_f32 v28, v176, v177, v178
  v_max3_f32 v29, v179, v180, v181
  v_max3_f32 v29, v29, v182, v183
  v_max3_f32 v28, v28, v184, v185
  v_max3_f32 v29, v29, v186, v187
  v_max3_f32 v28, v28, v188, v189
  v_max3_f32 v29, v29, v190, v191
  v_max_f32 v28, v28, v29
  v_mul_f32 v28, s78, v28
  v_pk_fma_f32 v[176:177], v[176:177], s[78:79], v[28:29] op_sel_hi:[1,0,0] neg_lo:[0,0,1] neg_hi:[0,0,1]
  v_pk_fma_f32 v[178:179], v[178:179], s[78:79], v[28:29] op_sel_hi:[1,0,0] neg_lo:[0,0,1] neg_hi:[0,0,1]
  v_pk_fma_f32 v[180:181], v[180:181], s[78:79], v[28:29] op_sel_hi:[1,0,0] neg_lo:[0,0,1] neg_hi:[0,0,1]
  v_pk_fma_f32 v[182:183], v[182:183], s[78:79], v[28:29] op_sel_hi:[1,0,0] neg_lo:[0,0,1] neg_hi:[0,0,1]
  v_pk_fma_f32 v[184:185], v[184:185], s[78:79], v[28:29] op_sel_hi:[1,0,0] neg_lo:[0,0,1] neg_hi:[0,0,1]
  v_pk_fma_f32 v[186:187], v[186:187], s[78:79], v[28:29] op_sel_hi:[1,0,0] neg_lo:[0,0,1] neg_hi:[0,0,1]
  v_pk_fma_f32 v[188:189], v[188:189], s[78:79], v[28:29] op_sel_hi:[1,0,0] neg_lo:[0,0,1] neg_hi:[0,0,1]
  v_pk_fma_f32 v[190:191], v[190:191], s[78:79], v[28:29] op_sel_hi:[1,0,0] neg_lo:[0,0,1] neg_hi:[0,0,1]
  v_exp_f32 v176, v176
  v_exp_f32 v177, v177
  v_exp_f32 v178, v178
  v_exp_f32 v179, v179
  v_exp_f32 v180, v180
  v_exp_f32 v181, v181
  v_exp_f32 v182, v182
  v_exp_f32 v183, v183
  v_exp_f32 v184, v184
  v_exp_f32 v185, v185
  v_exp_f32 v186, v186
  v_exp_f32 v187, v187
  v_exp_f32 v188, v188
  v_exp_f32 v189, v189
  v_exp_f32 v190, v190
  v_exp_f32 v191, v191
  v_pk_add_f32 v[72:73], v[176:177], v[184:185]
  v_pk_add_f32 v[74:75], v[178:179], v[186:187]
  v_pk_add_f32 v[76:77], v[180:181], v[188:189]
  v_pk_add_f32 v[78:79], v[182:183], v[190:191]
  v_pk_add_f32 v[72:73], v[72:73], v[76:77]
  v_pk_add_f32 v[74:75], v[74:75], v[78:79]
  v_pk_add_f32 v[72:73], v[72:73], v[74:75]
  v_add_f32 v28, v72, v73
  v_rcp_f32_e64 v28, v28
  s_nop 0
  v_pk_mul_f32 v[176:177], v[176:177], v[28:29] op_sel_hi:[1,0]
  v_pk_mul_f32 v[178:179], v[178:179], v[28:29] op_sel_hi:[1,0]
  v_pk_mul_f32 v[180:181], v[180:181], v[28:29] op_sel_hi:[1,0]
  v_pk_mul_f32 v[182:183], v[182:183], v[28:29] op_sel_hi:[1,0]
  v_pk_mul_f32 v[184:185], v[184:185], v[28:29] op_sel_hi:[1,0]
  v_pk_mul_f32 v[186:187], v[186:187], v[28:29] op_sel_hi:[1,0]
  v_pk_mul_f32 v[188:189], v[188:189], v[28:29] op_sel_hi:[1,0]
  v_pk_mul_f32 v[190:191], v[190:191], v[28:29] op_sel_hi:[1,0]
  v_cvt_pk_bf16_f32 v72, v176, v177
  v_cvt_pk_bf16_f32 v73, v178, v179
  v_cvt_pk_bf16_f32 v74, v180, v181
  v_cvt_pk_bf16_f32 v75, v182, v183
  v_cvt_pk_bf16_f32 v76, v184, v185
  v_cvt_pk_bf16_f32 v77, v186, v187
  v_cvt_pk_bf16_f32 v78, v188, v189
  v_cvt_pk_bf16_f32 v79, v190, v191
  v_max3_f32 v28, v192, v193, v194
  v_max3_f32 v29, v195, v196, v197
  v_max3_f32 v29, v29, v198, v199
  v_max3_f32 v28, v28, v200, v201
  v_max3_f32 v29, v29, v202, v203
  v_max3_f32 v28, v28, v204, v205
  v_max3_f32 v29, v29, v206, v207
  v_max_f32 v28, v28, v29
  v_mul_f32 v28, s78, v28
  v_pk_fma_f32 v[192:193], v[192:193], s[78:79], v[28:29] op_sel_hi:[1,0,0] neg_lo:[0,0,1] neg_hi:[0,0,1]
  v_pk_fma_f32 v[194:195], v[194:195], s[78:79], v[28:29] op_sel_hi:[1,0,0] neg_lo:[0,0,1] neg_hi:[0,0,1]
  v_pk_fma_f32 v[196:197], v[196:197], s[78:79], v[28:29] op_sel_hi:[1,0,0] neg_lo:[0,0,1] neg_hi:[0,0,1]
  v_pk_fma_f32 v[198:199], v[198:199], s[78:79], v[28:29] op_sel_hi:[1,0,0] neg_lo:[0,0,1] neg_hi:[0,0,1]
  v_pk_fma_f32 v[200:201], v[200:201], s[78:79], v[28:29] op_sel_hi:[1,0,0] neg_lo:[0,0,1] neg_hi:[0,0,1]
  v_pk_fma_f32 v[202:203], v[202:203], s[78:79], v[28:29] op_sel_hi:[1,0,0] neg_lo:[0,0,1] neg_hi:[0,0,1]
  v_pk_fma_f32 v[204:205], v[204:205], s[78:79], v[28:29] op_sel_hi:[1,0,0] neg_lo:[0,0,1] neg_hi:[0,0,1]
  v_pk_fma_f32 v[206:207], v[206:207], s[78:79], v[28:29] op_sel_hi:[1,0,0] neg_lo:[0,0,1] neg_hi:[0,0,1]
  v_exp_f32 v192, v192
  v_exp_f32 v193, v193
  v_exp_f32 v194, v194
  v_exp_f32 v195, v195
  v_exp_f32 v196, v196
  v_exp_f32 v197, v197
  v_exp_f32 v198, v198
  v_exp_f32 v199, v199
  v_exp_f32 v200, v200
  v_exp_f32 v201, v201
  v_exp_f32 v202, v202
  v_exp_f32 v203, v203
  v_exp_f32 v204, v204
  v_exp_f32 v205, v205
  v_exp_f32 v206, v206
  v_exp_f32 v207, v207
  v_pk_add_f32 v[80:81], v[192:193], v[200:201]
  v_pk_add_f32 v[82:83], v[194:195], v[202:203]
  v_pk_add_f32 v[84:85], v[196:197], v[204:205]
  v_pk_add_f32 v[86:87], v[198:199], v[206:207]
  v_pk_add_f32 v[80:81], v[80:81], v[84:85]
  v_pk_add_f32 v[82:83], v[82:83], v[86:87]
  v_pk_add_f32 v[80:81], v[80:81], v[82:83]
  v_add_f32 v28, v80, v81
  v_rcp_f32_e64 v28, v28
  s_nop 0
  v_pk_mul_f32 v[192:193], v[192:193], v[28:29] op_sel_hi:[1,0]
  v_pk_mul_f32 v[194:195], v[194:195], v[28:29] op_sel_hi:[1,0]
  v_pk_mul_f32 v[196:197], v[196:197], v[28:29] op_sel_hi:[1,0]
  v_pk_mul_f32 v[198:199], v[198:199], v[28:29] op_sel_hi:[1,0]
  v_pk_mul_f32 v[200:201], v[200:201], v[28:29] op_sel_hi:[1,0]
  v_pk_mul_f32 v[202:203], v[202:203], v[28:29] op_sel_hi:[1,0]
  v_pk_mul_f32 v[204:205], v[204:205], v[28:29] op_sel_hi:[1,0]
  v_pk_mul_f32 v[206:207], v[206:207], v[28:29] op_sel_hi:[1,0]
  v_cvt_pk_bf16_f32 v80, v192, v193
  v_cvt_pk_bf16_f32 v81, v194, v195
  v_cvt_pk_bf16_f32 v82, v196, v197
  v_cvt_pk_bf16_f32 v83, v198, v199
  v_cvt_pk_bf16_f32 v84, v200, v201
  v_cvt_pk_bf16_f32 v85, v202, v203
  v_cvt_pk_bf16_f32 v86, v204, v205
  v_cvt_pk_bf16_f32 v87, v206, v207
  v_max3_f32 v28, v208, v209, v210
  v_max3_f32 v29, v211, v212, v213
  v_max3_f32 v29, v29, v214, v215
  v_max3_f32 v28, v28, v216, v217
  v_max3_f32 v29, v29, v218, v219
  v_max3_f32 v28, v28, v220, v221
  v_max3_f32 v29, v29, v222, v223
  v_max_f32 v28, v28, v29
  v_mul_f32 v28, s78, v28
  v_pk_fma_f32 v[208:209], v[208:209], s[78:79], v[28:29] op_sel_hi:[1,0,0] neg_lo:[0,0,1] neg_hi:[0,0,1]
  v_pk_fma_f32 v[210:211], v[210:211], s[78:79], v[28:29] op_sel_hi:[1,0,0] neg_lo:[0,0,1] neg_hi:[0,0,1]
  v_pk_fma_f32 v[212:213], v[212:213], s[78:79], v[28:29] op_sel_hi:[1,0,0] neg_lo:[0,0,1] neg_hi:[0,0,1]
  v_pk_fma_f32 v[214:215], v[214:215], s[78:79], v[28:29] op_sel_hi:[1,0,0] neg_lo:[0,0,1] neg_hi:[0,0,1]
  v_pk_fma_f32 v[216:217], v[216:217], s[78:79], v[28:29] op_sel_hi:[1,0,0] neg_lo:[0,0,1] neg_hi:[0,0,1]
  v_pk_fma_f32 v[218:219], v[218:219], s[78:79], v[28:29] op_sel_hi:[1,0,0] neg_lo:[0,0,1] neg_hi:[0,0,1]
  v_pk_fma_f32 v[220:221], v[220:221], s[78:79], v[28:29] op_sel_hi:[1,0,0] neg_lo:[0,0,1] neg_hi:[0,0,1]
  v_pk_fma_f32 v[222:223], v[222:223], s[78:79], v[28:29] op_sel_hi:[1,0,0] neg_lo:[0,0,1] neg_hi:[0,0,1]
  v_exp_f32 v208, v208
  v_exp_f32 v209, v209
  v_exp_f32 v210, v210
  v_exp_f32 v211, v211
  v_exp_f32 v212, v212
  v_exp_f32 v213, v213
  v_exp_f32 v214, v214
  v_exp_f32 v215, v215
  v_exp_f32 v216, v216
  v_exp_f32 v217, v217
  v_exp_f32 v218, v218
  v_exp_f32 v219, v219
  v_exp_f32 v220, v220
  v_exp_f32 v221, v221
  v_exp_f32 v222, v222
  v_exp_f32 v223, v223
  v_pk_add_f32 v[88:89], v[208:209], v[216:217]
  v_pk_add_f32 v[90:91], v[210:211], v[218:219]
  v_pk_add_f32 v[92:93], v[212:213], v[220:221]
  v_pk_add_f32 v[94:95], v[214:215], v[222:223]
  v_pk_add_f32 v[88:89], v[88:89], v[92:93]
  v_pk_add_f32 v[90:91], v[90:91], v[94:95]
  v_pk_add_f32 v[88:89], v[88:89], v[90:91]
  v_add_f32 v28, v88, v89
  v_rcp_f32_e64 v28, v28
  s_nop 0
  v_pk_mul_f32 v[208:209], v[208:209], v[28:29] op_sel_hi:[1,0]
  v_pk_mul_f32 v[210:211], v[210:211], v[28:29] op_sel_hi:[1,0]
  v_pk_mul_f32 v[212:213], v[212:213], v[28:29] op_sel_hi:[1,0]
  v_pk_mul_f32 v[214:215], v[214:215], v[28:29] op_sel_hi:[1,0]
  v_pk_mul_f32 v[216:217], v[216:217], v[28:29] op_sel_hi:[1,0]
  v_pk_mul_f32 v[218:219], v[218:219], v[28:29] op_sel_hi:[1,0]
  v_pk_mul_f32 v[220:221], v[220:221], v[28:29] op_sel_hi:[1,0]
  v_pk_mul_f32 v[222:223], v[222:223], v[28:29] op_sel_hi:[1,0]
  v_cvt_pk_bf16_f32 v88, v208, v209
  v_cvt_pk_bf16_f32 v89, v210, v211
  v_cvt_pk_bf16_f32 v90, v212, v213
  v_cvt_pk_bf16_f32 v91, v214, v215
  v_cvt_pk_bf16_f32 v92, v216, v217
  v_cvt_pk_bf16_f32 v93, v218, v219
  v_cvt_pk_bf16_f32 v94, v220, v221
  v_cvt_pk_bf16_f32 v95, v222, v223
  s_barrier
  ds_read_b128 v[96:99], v30 offset:0
  ds_read_b128 v[100:103], v31 offset:0
  ds_read_b128 v[104:107], v30 offset:2048
  ds_read_b128 v[108:111], v31 offset:2048
  ds_read_b128 v[112:115], v30 offset:4096
  ds_read_b128 v[116:119], v31 offset:4096
  ds_read_b128 v[120:123], v30 offset:6144
  ds_read_b128 v[124:127], v31 offset:6144
  s_waitcnt lgkmcnt(7)
  v_mfma_f32_32x32x16_bf16 v[160:175], v[96:99], v[64:67], 0
  s_waitcnt lgkmcnt(6)
  v_mfma_f32_32x32x16_bf16 v[160:175], v[100:103], v[68:71], v[160:175]
  s_waitcnt lgkmcnt(5)
  v_mfma_f32_32x32x16_bf16 v[176:191], v[104:107], v[72:75], 0
  s_waitcnt lgkmcnt(4)
  v_mfma_f32_32x32x16_bf16 v[176:191], v[108:111], v[76:79], v[176:191]
  s_waitcnt lgkmcnt(3)
  v_mfma_f32_32x32x16_bf16 v[192:207], v[112:115], v[80:83], 0
  s_waitcnt lgkmcnt(2)
  v_mfma_f32_32x32x16_bf16 v[192:207], v[116:119], v[84:87], v[192:207]
  s_waitcnt lgkmcnt(1)
  v_mfma_f32_32x32x16_bf16 v[208:223], v[120:123], v[88:91], 0
  s_waitcnt lgkmcnt(0)
  v_mfma_f32_32x32x16_bf16 v[208:223], v[124:127], v[92:95], v[208:223]
  v_add_f32 v20, v168, v169
  v_add_f32 v20, v20, v170
  v_add_f32 v20, v20, v171
  v_add_f32 v20, v20, v172
  v_add_f32 v20, v20, v173
  v_add_f32 v20, v20, v174
  v_add_f32 v20, v20, v175
  v_add_f32 v21, v184, v185
  v_add_f32 v21, v21, v186
  v_add_f32 v21, v21, v187
  v_add_f32 v21, v21, v188
  v_add_f32 v21, v21, v189
  v_add_f32 v21, v21, v190
  v_add_f32 v21, v21, v191
  v_add_f32 v22, v200, v201
  v_add_f32 v22, v22, v202
  v_add_f32 v22, v22, v203
  v_add_f32 v22, v22, v204
  v_add_f32 v22, v22, v205
  v_add_f32 v22, v22, v206
  v_add_f32 v22, v22, v207
  v_add_f32 v23, v216, v217
  v_add_f32 v23, v23, v218
  v_add_f32 v23, v23, v219
  v_add_f32 v23, v23, v220
  v_add_f32 v23, v23, v221
  v_add_f32 v23, v23, v222
  v_add_f32 v23, v23, v223
  s_nop 0
  v_permlane32_swap_b32 v20, v21
  v_permlane32_swap_b32 v22, v23
  v_add_f32 v20, v20, v21
  v_add_f32 v22, v22, v23
  v_add_f32 v20, 0x358637bd, v20
  v_add_f32 v22, 0x358637bd, v22
  v_rcp_f32 v20, v20
  v_rcp_f32 v22, v22
  v_mov_b32 v21, v20
  v_mov_b32 v23, v22
  s_nop 0
  v_permlane32_swap_b32 v20, v21
  v_permlane32_swap_b32 v22, v23
  v_mul_f32 v160, v20, v160
  v_mul_f32 v161, v20, v161
  v_mul_f32 v162, v20, v162
  v_mul_f32 v163, v20, v163
  v_mul_f32 v164, v20, v164
  v_mul_f32 v165, v20, v165
  v_mul_f32 v166, v20, v166
  v_mul_f32_e64 v167, v20, v167
  v_cvt_pk_bf16_f32 v32, v160, v161
  v_cvt_pk_bf16_f32 v33, v162, v163
  v_cvt_pk_bf16_f32 v34, v164, v165
  v_cvt_pk_bf16_f32 v35, v166, v167
  buffer_store_dwordx4 v[32:35], v1, s[48:51], s31 offen offset:0 sc1
  v_mul_f32 v176, v21, v176
  v_mul_f32 v177, v21, v177
  v_mul_f32 v178, v21, v178
  v_mul_f32 v179, v21, v179
  v_mul_f32 v180, v21, v180
  v_mul_f32 v181, v21, v181
  v_mul_f32 v182, v21, v182
  v_mul_f32 v183, v21, v183
  v_cvt_pk_bf16_f32 v36, v176, v177
  v_cvt_pk_bf16_f32 v37, v178, v179
  v_cvt_pk_bf16_f32 v38, v180, v181
  v_cvt_pk_bf16_f32 v39, v182, v183
  buffer_store_dwordx4 v[36:39], v1, s[48:51], s31 offen offset:1024 sc1
  v_mul_f32 v192, v22, v192
  v_mul_f32 v193, v22, v193
  v_mul_f32 v194, v22, v194
  v_mul_f32 v195, v22, v195
  v_mul_f32 v196, v22, v196
  v_mul_f32 v197, v22, v197
  v_mul_f32 v198, v22, v198
  v_mul_f32 v199, v22, v199
  v_cvt_pk_bf16_f32 v40, v192, v193
  v_cvt_pk_bf16_f32 v41, v194, v195
  v_cvt_pk_bf16_f32 v42, v196, v197
  v_cvt_pk_bf16_f32 v43, v198, v199
  buffer_store_dwordx4 v[40:43], v1, s[48:51], s31 offen offset:2048 sc1
  v_mul_f32 v208, v23, v208
  v_mul_f32 v209, v23, v209
  v_mul_f32 v210, v23, v210
  v_mul_f32 v211, v23, v211
  v_mul_f32 v212, v23, v212
  v_mul_f32 v213, v23, v213
  v_mul_f32 v214, v23, v214
  v_mul_f32 v215, v23, v215
  v_cvt_pk_bf16_f32 v44, v208, v209
  v_cvt_pk_bf16_f32 v45, v210, v211
  v_cvt_pk_bf16_f32 v46, v212, v213
  v_cvt_pk_bf16_f32 v47, v214, v215
  buffer_store_dwordx4 v[44:47], v1, s[48:51], s31 offen offset:3072 sc1
  s_branch L_mf2
L_mf:
  s_mov_b32 s56, s16
  s_mov_b32 s57, s17
  s_mov_b32 s58, 2752
  s_mov_b32 s59, 0x20000
  v_lshrrev_b32 v28, 5, v0
  v_lshlrev_b32_e64 v28, 28, v28
  v_lshl_add_u32 v28, v0, 1, v28
  s_mul_i32 s74, s62, 43
  s_add_u32 s75, s74, 50
  s_lshr_b32 s75, s75, 3
  s_add_u32 s74, s74, 7
  s_lshr_b32 s74, s74, 3
  s_sub_u32 s75, s75, s74
  s_lshr_b32 s65, s63, 1
  s_add_u32 s74, s74, s65
  s_sub_u32 s75, 6, s75
  s_mul_i32 s3, s75, s65
  s_lshl_b32 s75, s74, 6
  buffer_load_ushort v168, v28, s[56:59], s75 offen offset:0
  buffer_load_ushort v172, v28, s[56:59], s75 offen offset:128
  buffer_load_ushort v176, v28, s[56:59], s75 offen offset:256
  s_lshl_b32 s75, s65, 6
  v_xor_b32_e64 v6, s75, v6
  v_add_u32 v7, 0x10000, v6
  v_add_u32 v8, 0x20000, v6
  s_and_b32 s72, s63, 1
  s_lshl_b32 s75, s72, 13
  s_add_u32 s75, s75, 57344
  v_add_u32 v2, s75, v2
  v_xor_b32 v3, 16, v2
  v_xor_b32_e64 v4, 64, v2
  v_xor_b32 v5, 0x50, v2
  s_lshl1_add_u32 s73, s61, s72
  s_mul_i32 s31, s73, 245760
  s_lshl_b32 s74, s74, 11
  s_add_u32 s31, s31, s74
  s_add_u32 s31, s31, 1048576
  s_lshl1_add_u32 s65, s62, s65
  s_lshl_b32 s12, s73, 5
  s_add_u32 s12, s12, s65
  s_lshl_b32 s12, s12, 7
  s_add_u32 s12, s12, 851968
  s_lshl4_add_u32 s70, s73, s65
  s_lshl_b32 s70, s70, 4
  s_add_u32 s70, s70, 131072
  v_lshrrev_b32 v28, 4, v0
  s_lshl_b32 s65, s65, 2
  v_add_u32 v28, s65, v28
  v_lshrrev_b32 v29, 1, v28
  v_lshrrev_b32 v30, 1, v0
  v_xor_b32 v29, v29, v30
  v_and_b32 v29, 7, v29
  v_lshlrev_b32_e64 v29, 4, v29
  v_lshl_add_u32 v28, v28, 7, v29
  v_and_b32_e64 v29, 1, v0
  v_lshl_add_u32 v28, v29, 3, v28
  v_add_u32 v10, s75, v28
  v_and_b32 v28, 15, v0
  v_lshlrev_b32_e64 v28, 3, v28
  v_add_u32 v11, 155648, v28
  v_mov_b32_e64 v16, 0
  s_mov_b32 s13, 0xbdd2d3e8
  v_mov_b32 v19, 0xc0135761
  v_mov_b32 v169, 0
  v_mov_b32 v170, 0
  v_mov_b32 v171, 0
  v_mov_b32 v173, 0
  v_mov_b32 v174, 0
  v_mov_b32 v175, 0
  v_mov_b32 v177, 0
  v_mov_b32 v178, 0
  v_mov_b32_e64 v179, 0
  v_mov_b32 v180, 0x3f803f80
  v_mov_b32 v181, 0x3f803f80
  v_mov_b32 v182, 0x3f803f80
  v_mov_b32 v183, 0x3f803f80
  s_waitcnt vmcnt(0) lgkmcnt(0)
  s_mul_i32 s68, s68, 1664525
  s_add_u32 s68, s68, 1013904223
  s_xor_b32 s69, s68, 0x9e3779b9
  v_mfma_f32_32x32x16_bf16 v[32:47], v[168:171], v[180:183], 0
  v_mfma_f32_32x32x16_bf16 v[48:63], v[168:171], v[180:183], 0
  v_mfma_f32_32x32x16_bf16 v[64:79], v[172:175], v[180:183], 0
  v_mfma_f32_32x32x16_bf16 v[80:95], v[172:175], v[180:183], 0
  v_mfma_f32_32x32x16_bf16 v[96:111], v[176:179], v[180:183], 0
  v_mfma_f32_32x32x16_bf16 v[112:127], v[176:179], v[180:183], 0
  s_barrier
  ds_read_b64_tr_b16 v[136:137], v7 offset:40960
  ds_read_b64_tr_b16 v[138:139], v7 offset:41472
  ds_read_b64_tr_b16 v[140:141], v7 offset:49152
  ds_read_b64_tr_b16 v[142:143], v7 offset:49664
  ds_read_b128 v[128:131], v2 offset:16384
  ds_read_b64_tr_b16 v[144:145], v7 offset:57344
  ds_read_b64_tr_b16 v[146:147], v7 offset:57856
  ds_read_b128 v[132:135], v2 offset:20480
  ds_read_b64_tr_b16 v[156:157], v7 offset:41984
  ds_read_b64_tr_b16 v[158:159], v7 offset:42496
  ds_read_b64_tr_b16 v[160:161], v7 offset:50176
  ds_read_b64_tr_b16 v[162:163], v7 offset:50688
  ds_read_b128 v[148:151], v3 offset:16384
  ds_read_b64_tr_b16 v[164:165], v7 offset:58368
  ds_read_b64_tr_b16 v[166:167], v7 offset:58880
  ds_read_b128 v[152:155], v3 offset:20480
  s_waitcnt lgkmcnt(11)
  v_mfma_f32_32x32x16_bf16 v[32:47], v[136:139], v[128:131], v[32:47]
  s_waitcnt lgkmcnt(8)
  v_mfma_f32_32x32x16_bf16 v[48:63], v[136:139], v[132:135], v[48:63]
  ds_read_b64_tr_b16 v[136:137], v7 offset:45056
  ds_read_b64_tr_b16 v[138:139], v7 offset:45568
  v_mfma_f32_32x32x16_bf16 v[64:79], v[140:143], v[128:131], v[64:79]
  ds_read_b64 v[12:13], v10 offset:16384
  v_mfma_f32_32x32x16_bf16 v[80:95], v[140:143], v[132:135], v[80:95]
  ds_read_b64_tr_b16 v[140:141], v7 offset:53248
  ds_read_b64_tr_b16 v[142:143], v7 offset:53760
  v_mfma_f32_32x32x16_bf16 v[96:111], v[144:147], v[128:131], v[96:111]
  ds_read_b128 v[128:131], v4 offset:16384
  v_mfma_f32_32x32x16_bf16 v[112:127], v[144:147], v[132:135], v[112:127]
  ds_read_b64_tr_b16 v[144:145], v7 offset:61440
  ds_read_b64_tr_b16 v[146:147], v7 offset:61952
  ds_read_b128 v[132:135], v4 offset:20480
  ds_read_b64 v[14:15], v11 offset:0
  s_waitcnt lgkmcnt(13)
  v_mfma_f32_32x32x16_bf16 v[32:47], v[156:159], v[148:151], v[32:47]
  s_waitcnt lgkmcnt(10)
  v_mfma_f32_32x32x16_bf16 v[48:63], v[156:159], v[152:155], v[48:63]
  ds_read_b64_tr_b16 v[156:157], v7 offset:46080
  ds_read_b64_tr_b16 v[158:159], v7 offset:46592
  v_mfma_f32_32x32x16_bf16 v[64:79], v[160:163], v[148:151], v[64:79]
  v_mfma_f32_32x32x16_bf16 v[80:95], v[160:163], v[152:155], v[80:95]
  ds_read_b64_tr_b16 v[160:161], v7 offset:54272
  ds_read_b64_tr_b16 v[162:163], v7 offset:54784
  v_mfma_f32_32x32x16_bf16 v[96:111], v[164:167], v[148:151], v[96:111]
  ds_read_b128 v[148:151], v5 offset:16384
  v_mfma_f32_32x32x16_bf16 v[112:127], v[164:167], v[152:155], v[112:127]
  ds_read_b64_tr_b16 v[164:165], v7 offset:62464
  ds_read_b64_tr_b16 v[166:167], v7 offset:62976
  ds_read_b128 v[152:155], v5 offset:20480
  s_waitcnt lgkmcnt(12)
  v_mfma_f32_32x32x16_bf16 v[32:47], v[136:139], v[128:131], v[32:47]
  s_waitcnt lgkmcnt(9)
  v_mfma_f32_32x32x16_bf16 v[48:63], v[136:139], v[132:135], v[48:63]
  v_mfma_f32_32x32x16_bf16 v[64:79], v[140:143], v[128:131], v[64:79]
  s_waitcnt lgkmcnt(0)
  s_barrier
  ds_read_b64_tr_b16 v[136:137], v8 offset:0
  ds_read_b64_tr_b16 v[138:139], v8 offset:512
  v_mfma_f32_32x32x16_bf16 v[80:95], v[140:143], v[132:135], v[80:95]
  ds_read_b64_tr_b16 v[140:141], v8 offset:8192
  ds_read_b64_tr_b16 v[142:143], v8 offset:8704
  v_mfma_f32_32x32x16_bf16 v[96:111], v[144:147], v[128:131], v[96:111]
  ds_read_b128 v[128:131], v2 offset:32768
  v_mfma_f32_32x32x16_bf16 v[112:127], v[144:147], v[132:135], v[112:127]
  ds_read_b64_tr_b16 v[144:145], v8 offset:16384
  ds_read_b64_tr_b16 v[146:147], v8 offset:16896
  ds_read_b128 v[132:135], v2 offset:36864
  v_mfma_f32_32x32x16_bf16 v[32:47], v[156:159], v[148:151], v[32:47]
  v_lshlrev_b32_e64 v28, 16, v12
  v_mfma_f32_32x32x16_bf16 v[48:63], v[156:159], v[152:155], v[48:63]
  ds_read_b64_tr_b16 v[156:157], v8 offset:1024
  ds_read_b64_tr_b16 v[158:159], v8 offset:1536
  v_lshlrev_b32 v29, 16, v14
  v_fmac_f32 v16, v28, v29
  v_mfma_f32_32x32x16_bf16 v[64:79], v[160:163], v[148:151], v[64:79]
  v_and_b32 v28, 0xffff0000, v12
  v_and_b32 v29, 0xffff0000, v14
  v_mfma_f32_32x32x16_bf16 v[80:95], v[160:163], v[152:155], v[80:95]
  ds_read_b64_tr_b16 v[160:161], v8 offset:9216
  ds_read_b64_tr_b16 v[162:163], v8 offset:9728
  v_fmac_f32 v16, v28, v29
  v_lshlrev_b32 v28, 16, v13
  v_mfma_f32_32x32x16_bf16 v[96:111], v[164:167], v[148:151], v[96:111]
  ds_read_b128 v[148:151], v3 offset:32768
  v_lshlrev_b32 v29, 16, v15
  v_fmac_f32 v16, v28, v29
  v_mfma_f32_32x32x16_bf16 v[112:127], v[164:167], v[152:155], v[112:127]
  ds_read_b64_tr_b16 v[164:165], v8 offset:17408
  ds_read_b64_tr_b16 v[166:167], v8 offset:17920
  ds_read_b128 v[152:155], v3 offset:36864
  v_and_b32 v28, 0xffff0000, v13
  v_and_b32 v29, 0xffff0000, v15
  v_fmac_f32 v16, v28, v29
  s_waitcnt lgkmcnt(11)
  v_mfma_f32_32x32x16_bf16 v[32:47], v[136:139], v[128:131], v[32:47]
  s_waitcnt lgkmcnt(8)
  v_mfma_f32_32x32x16_bf16 v[48:63], v[136:139], v[132:135], v[48:63]
  ds_read_b64_tr_b16 v[136:137], v8 offset:4096
  ds_read_b64_tr_b16 v[138:139], v8 offset:4608
  v_mfma_f32_32x32x16_bf16 v[64:79], v[140:143], v[128:131], v[64:79]
  ds_read_b64 v[12:13], v10 offset:32768
  v_mfma_f32_32x32x16_bf16 v[80:95], v[140:143], v[132:135], v[80:95]
  ds_read_b64_tr_b16 v[140:141], v8 offset:12288
  ds_read_b64_tr_b16 v[142:143], v8 offset:12800
  v_mfma_f32_32x32x16_bf16 v[96:111], v[144:147], v[128:131], v[96:111]
  ds_read_b128 v[128:131], v4 offset:32768
  v_mfma_f32_32x32x16_bf16 v[112:127], v[144:147], v[132:135], v[112:127]
  ds_read_b64_tr_b16 v[144:145], v8 offset:20480
  ds_read_b64_tr_b16 v[146:147], v8 offset:20992
  ds_read_b128 v[132:135], v4 offset:36864
  ds_read_b64 v[14:15], v11 offset:128
  s_waitcnt lgkmcnt(13)
  v_mfma_f32_32x32x16_bf16 v[32:47], v[156:159], v[148:151], v[32:47]
  s_waitcnt lgkmcnt(10)
  v_mfma_f32_32x32x16_bf16 v[48:63], v[156:159], v[152:155], v[48:63]
  ds_read_b64_tr_b16 v[156:157], v8 offset:5120
  ds_read_b64_tr_b16 v[158:159], v8 offset:5632
  v_mfma_f32_32x32x16_bf16 v[64:79], v[160:163], v[148:151], v[64:79]
  v_mfma_f32_32x32x16_bf16 v[80:95], v[160:163], v[152:155], v[80:95]
  ds_read_b64_tr_b16 v[160:161], v8 offset:13312
  ds_read_b64_tr_b16 v[162:163], v8 offset:13824
  v_mfma_f32_32x32x16_bf16 v[96:111], v[164:167], v[148:151], v[96:111]
  ds_read_b128 v[148:151], v5 offset:32768
  v_mfma_f32_32x32x16_bf16 v[112:127], v[164:167], v[152:155], v[112:127]
  ds_read_b64_tr_b16 v[164:165], v8 offset:21504
  ds_read_b64_tr_b16 v[166:167], v8 offset:22016
  ds_read_b128 v[152:155], v5 offset:36864
  s_waitcnt lgkmcnt(12)
  v_mfma_f32_32x32x16_bf16 v[32:47], v[136:139], v[128:131], v[32:47]
  s_waitcnt lgkmcnt(9)
  v_mfma_f32_32x32x16_bf16 v[48:63], v[136:139], v[132:135], v[48:63]
  v_mfma_f32_32x32x16_bf16 v[64:79], v[140:143], v[128:131], v[64:79]
  s_waitcnt lgkmcnt(0)
  s_barrier
  ds_read_b64_tr_b16 v[136:137], v6 offset:32768
  ds_read_b64_tr_b16 v[138:139], v6 offset:33280
  v_mfma_f32_32x32x16_bf16 v[80:95], v[140:143], v[132:135], v[80:95]
  ds_read_b64_tr_b16 v[140:141], v6 offset:40960
  ds_read_b64_tr_b16 v[142:143], v6 offset:41472
  v_mfma_f32_32x32x16_bf16 v[96:111], v[144:147], v[128:131], v[96:111]
  ds_read_b128 v[128:131], v2 offset:0
  v_mfma_f32_32x32x16_bf16 v[112:127], v[144:147], v[132:135], v[112:127]
  ds_read_b64_tr_b16 v[144:145], v6 offset:49152
  ds_read_b64_tr_b16 v[146:147], v6 offset:49664
  ds_read_b128 v[132:135], v2 offset:4096
  v_mfma_f32_32x32x16_bf16 v[32:47], v[156:159], v[148:151], v[32:47]
  v_lshlrev_b32 v28, 16, v12
  v_mfma_f32_32x32x16_bf16 v[48:63], v[156:159], v[152:155], v[48:63]
  ds_read_b64_tr_b16 v[156:157], v6 offset:33792
  ds_read_b64_tr_b16 v[158:159], v6 offset:34304
  v_lshlrev_b32 v29, 16, v14
  v_fmac_f32 v16, v28, v29
  v_mfma_f32_32x32x16_bf16 v[64:79], v[160:163], v[148:151], v[64:79]
  v_and_b32 v28, 0xffff0000, v12
  v_and_b32 v29, 0xffff0000, v14
  v_mfma_f32_32x32x16_bf16 v[80:95], v[160:163], v[152:155], v[80:95]
  ds_read_b64_tr_b16 v[160:161], v6 offset:41984
  ds_read_b64_tr_b16 v[162:163], v6 offset:42496
  v_fmac_f32 v16, v28, v29
  v_lshlrev_b32 v28, 16, v13
  v_mfma_f32_32x32x16_bf16 v[96:111], v[164:167], v[148:151], v[96:111]
  ds_read_b128 v[148:151], v3 offset:0
  v_lshlrev_b32 v29, 16, v15
  v_fmac_f32 v16, v28, v29
  v_mfma_f32_32x32x16_bf16 v[112:127], v[164:167], v[152:155], v[112:127]
  ds_read_b64_tr_b16 v[164:165], v6 offset:50176
  ds_read_b64_tr_b16 v[166:167], v6 offset:50688
  ds_read_b128 v[152:155], v3 offset:4096
  v_and_b32 v28, 0xffff0000, v13
  v_and_b32 v29, 0xffff0000, v15
  v_fmac_f32 v16, v28, v29
  s_waitcnt lgkmcnt(11)
  v_mfma_f32_32x32x16_bf16 v[32:47], v[136:139], v[128:131], v[32:47]
  s_waitcnt lgkmcnt(8)
  v_mfma_f32_32x32x16_bf16 v[48:63], v[136:139], v[132:135], v[48:63]
  ds_read_b64_tr_b16 v[136:137], v6 offset:36864
  ds_read_b64_tr_b16 v[138:139], v6 offset:37376
  v_mfma_f32_32x32x16_bf16 v[64:79], v[140:143], v[128:131], v[64:79]
  ds_read_b64 v[12:13], v10 offset:0
  v_mfma_f32_32x32x16_bf16 v[80:95], v[140:143], v[132:135], v[80:95]
  ds_read_b64_tr_b16 v[140:141], v6 offset:45056
  ds_read_b64_tr_b16 v[142:143], v6 offset:45568
  v_mfma_f32_32x32x16_bf16 v[96:111], v[144:147], v[128:131], v[96:111]
  ds_read_b128 v[128:131], v4 offset:0
  v_mfma_f32_32x32x16_bf16 v[112:127], v[144:147], v[132:135], v[112:127]
  ds_read_b64_tr_b16 v[144:145], v6 offset:53248
  ds_read_b64_tr_b16 v[146:147], v6 offset:53760
  ds_read_b128 v[132:135], v4 offset:4096
  ds_read_b64 v[14:15], v11 offset:256
  s_waitcnt lgkmcnt(13)
  v_mfma_f32_32x32x16_bf16 v[32:47], v[156:159], v[148:151], v[32:47]
  s_waitcnt lgkmcnt(10)
  v_mfma_f32_32x32x16_bf16 v[48:63], v[156:159], v[152:155], v[48:63]
  ds_read_b64_tr_b16 v[156:157], v6 offset:37888
  ds_read_b64_tr_b16 v[158:159], v6 offset:38400
  v_mfma_f32_32x32x16_bf16 v[64:79], v[160:163], v[148:151], v[64:79]
  v_mfma_f32_32x32x16_bf16 v[80:95], v[160:163], v[152:155], v[80:95]
  ds_read_b64_tr_b16 v[160:161], v6 offset:46080
  ds_read_b64_tr_b16 v[162:163], v6 offset:46592
  v_mfma_f32_32x32x16_bf16 v[96:111], v[164:167], v[148:151], v[96:111]
  ds_read_b128 v[148:151], v5 offset:0
  v_mfma_f32_32x32x16_bf16 v[112:127], v[164:167], v[152:155], v[112:127]
  ds_read_b64_tr_b16 v[164:165], v6 offset:54272
  ds_read_b64_tr_b16 v[166:167], v6 offset:54784
  ds_read_b128 v[152:155], v5 offset:4096
  s_waitcnt lgkmcnt(12)
  v_mfma_f32_32x32x16_bf16 v[32:47], v[136:139], v[128:131], v[32:47]
  s_waitcnt lgkmcnt(9)
  v_mfma_f32_32x32x16_bf16 v[48:63], v[136:139], v[132:135], v[48:63]
  v_mfma_f32_32x32x16_bf16 v[64:79], v[140:143], v[128:131], v[64:79]
  s_waitcnt lgkmcnt(0)
  s_barrier
  ds_read_b64_tr_b16 v[136:137], v7 offset:40960
  ds_read_b64_tr_b16 v[138:139], v7 offset:41472
  v_mfma_f32_32x32x16_bf16 v[80:95], v[140:143], v[132:135], v[80:95]
  ds_read_b64_tr_b16 v[140:141], v7 offset:49152
  ds_read_b64_tr_b16 v[142:143], v7 offset:49664
  v_mfma_f32_32x32x16_bf16 v[96:111], v[144:147], v[128:131], v[96:111]
  ds_read_b128 v[128:131], v2 offset:16384
  v_mfma_f32_32x32x16_bf16 v[112:127], v[144:147], v[132:135], v[112:127]
  ds_read_b64_tr_b16 v[144:145], v7 offset:57344
  ds_read_b64_tr_b16 v[146:147], v7 offset:57856
  ds_read_b128 v[132:135], v2 offset:20480
  v_mfma_f32_32x32x16_bf16 v[32:47], v[156:159], v[148:151], v[32:47]
  v_lshlrev_b32 v28, 16, v12
  v_mfma_f32_32x32x16_bf16 v[48:63], v[156:159], v[152:155], v[48:63]
  ds_read_b64_tr_b16 v[156:157], v7 offset:41984
  ds_read_b64_tr_b16 v[158:159], v7 offset:42496
  v_lshlrev_b32 v29, 16, v14
  v_fmac_f32 v16, v28, v29
  v_mfma_f32_32x32x16_bf16 v[64:79], v[160:163], v[148:151], v[64:79]
  v_and_b32 v28, 0xffff0000, v12
  v_and_b32 v29, 0xffff0000, v14
  v_mfma_f32_32x32x16_bf16 v[80:95], v[160:163], v[152:155], v[80:95]
  ds_read_b64_tr_b16 v[160:161], v7 offset:50176
  ds_read_b64_tr_b16 v[162:163], v7 offset:50688
  v_fmac_f32 v16, v28, v29
  v_lshlrev_b32 v28, 16, v13
  v_mfma_f32_32x32x16_bf16 v[96:111], v[164:167], v[148:151], v[96:111]
  ds_read_b128 v[148:151], v3 offset:16384
  v_lshlrev_b32 v29, 16, v15
  v_fmac_f32 v16, v28, v29
  v_mfma_f32_32x32x16_bf16 v[112:127], v[164:167], v[152:155], v[112:127]
  ds_read_b64_tr_b16 v[164:165], v7 offset:58368
  ds_read_b64_tr_b16 v[166:167], v7 offset:58880
  ds_read_b128 v[152:155], v3 offset:20480
  v_and_b32 v28, 0xffff0000, v13
  v_and_b32 v29, 0xffff0000, v15
  v_fmac_f32 v16, v28, v29
  s_waitcnt lgkmcnt(11)
  v_mfma_f32_32x32x16_bf16 v[32:47], v[136:139], v[128:131], v[32:47]
  s_waitcnt lgkmcnt(8)
  v_mfma_f32_32x32x16_bf16 v[48:63], v[136:139], v[132:135], v[48:63]
  ds_read_b64_tr_b16 v[136:137], v7 offset:45056
  ds_read_b64_tr_b16 v[138:139], v7 offset:45568
  v_mfma_f32_32x32x16_bf16 v[64:79], v[140:143], v[128:131], v[64:79]
  ds_read_b64 v[12:13], v10 offset:16384
  v_mfma_f32_32x32x16_bf16 v[80:95], v[140:143], v[132:135], v[80:95]
  ds_read_b64_tr_b16 v[140:141], v7 offset:53248
  ds_read_b64_tr_b16 v[142:143], v7 offset:53760
  v_mfma_f32_32x32x16_bf16 v[96:111], v[144:147], v[128:131], v[96:111]
  ds_read_b128 v[128:131], v4 offset:16384
  v_mfma_f32_32x32x16_bf16 v[112:127], v[144:147], v[132:135], v[112:127]
  ds_read_b64_tr_b16 v[144:145], v7 offset:61440
  ds_read_b64_tr_b16 v[146:147], v7 offset:61952
  ds_read_b128 v[132:135], v4 offset:20480
  ds_read_b64 v[14:15], v11 offset:384
  s_waitcnt lgkmcnt(13)
  v_mfma_f32_32x32x16_bf16 v[32:47], v[156:159], v[148:151], v[32:47]
  s_waitcnt lgkmcnt(10)
  v_mfma_f32_32x32x16_bf16 v[48:63], v[156:159], v[152:155], v[48:63]
  ds_read_b64_tr_b16 v[156:157], v7 offset:46080
  ds_read_b64_tr_b16 v[158:159], v7 offset:46592
  v_mfma_f32_32x32x16_bf16 v[64:79], v[160:163], v[148:151], v[64:79]
  v_mfma_f32_32x32x16_bf16 v[80:95], v[160:163], v[152:155], v[80:95]
  ds_read_b64_tr_b16 v[160:161], v7 offset:54272
  ds_read_b64_tr_b16 v[162:163], v7 offset:54784
  v_mfma_f32_32x32x16_bf16 v[96:111], v[164:167], v[148:151], v[96:111]
  ds_read_b128 v[148:151], v5 offset:16384
  v_mfma_f32_32x32x16_bf16 v[112:127], v[164:167], v[152:155], v[112:127]
  ds_read_b64_tr_b16 v[164:165], v7 offset:62464
  ds_read_b64_tr_b16 v[166:167], v7 offset:62976
  ds_read_b128 v[152:155], v5 offset:20480
  s_waitcnt lgkmcnt(12)
  v_mfma_f32_32x32x16_bf16 v[32:47], v[136:139], v[128:131], v[32:47]
  s_waitcnt lgkmcnt(9)
  v_mfma_f32_32x32x16_bf16 v[48:63], v[136:139], v[132:135], v[48:63]
  v_mfma_f32_32x32x16_bf16 v[64:79], v[140:143], v[128:131], v[64:79]
  s_waitcnt lgkmcnt(0)
  s_barrier
  ds_read_b64_tr_b16 v[136:137], v8 offset:0
  ds_read_b64_tr_b16 v[138:139], v8 offset:512
  v_mfma_f32_32x32x16_bf16 v[80:95], v[140:143], v[132:135], v[80:95]
  ds_read_b64_tr_b16 v[140:141], v8 offset:8192
  ds_read_b64_tr_b16 v[142:143], v8 offset:8704
  v_mfma_f32_32x32x16_bf16 v[96:111], v[144:147], v[128:131], v[96:111]
  ds_read_b128 v[128:131], v2 offset:32768
  v_mfma_f32_32x32x16_bf16 v[112:127], v[144:147], v[132:135], v[112:127]
  ds_read_b64_tr_b16 v[144:145], v8 offset:16384
  ds_read_b64_tr_b16 v[146:147], v8 offset:16896
  ds_read_b128 v[132:135], v2 offset:36864
  v_mfma_f32_32x32x16_bf16 v[32:47], v[156:159], v[148:151], v[32:47]
  v_lshlrev_b32 v28, 16, v12
  v_mfma_f32_32x32x16_bf16 v[48:63], v[156:159], v[152:155], v[48:63]
  ds_read_b64_tr_b16 v[156:157], v8 offset:1024
  ds_read_b64_tr_b16 v[158:159], v8 offset:1536
  v_lshlrev_b32 v29, 16, v14
  v_fmac_f32 v16, v28, v29
  v_mfma_f32_32x32x16_bf16 v[64:79], v[160:163], v[148:151], v[64:79]
  v_and_b32 v28, 0xffff0000, v12
  v_and_b32 v29, 0xffff0000, v14
  v_mfma_f32_32x32x16_bf16 v[80:95], v[160:163], v[152:155], v[80:95]
  ds_read_b64_tr_b16 v[160:161], v8 offset:9216
  ds_read_b64_tr_b16 v[162:163], v8 offset:9728
  v_fmac_f32 v16, v28, v29
  v_lshlrev_b32 v28, 16, v13
  v_mfma_f32_32x32x16_bf16 v[96:111], v[164:167], v[148:151], v[96:111]
  ds_read_b128 v[148:151], v3 offset:32768
  v_lshlrev_b32 v29, 16, v15
  v_fmac_f32 v16, v28, v29
  v_mfma_f32_32x32x16_bf16 v[112:127], v[164:167], v[152:155], v[112:127]
  ds_read_b64_tr_b16 v[164:165], v8 offset:17408
  ds_read_b64_tr_b16 v[166:167], v8 offset:17920
  ds_read_b128 v[152:155], v3 offset:36864
  v_and_b32 v28, 0xffff0000, v13
  v_and_b32 v29, 0xffff0000, v15
  v_fmac_f32 v16, v28, v29
  s_waitcnt lgkmcnt(11)
  v_mfma_f32_32x32x16_bf16 v[32:47], v[136:139], v[128:131], v[32:47]
  s_waitcnt lgkmcnt(8)
  v_mfma_f32_32x32x16_bf16 v[48:63], v[136:139], v[132:135], v[48:63]
  ds_read_b64_tr_b16 v[136:137], v8 offset:4096
  ds_read_b64_tr_b16 v[138:139], v8 offset:4608
  v_mfma_f32_32x32x16_bf16 v[64:79], v[140:143], v[128:131], v[64:79]
  ds_read_b64 v[12:13], v10 offset:32768
  v_mfma_f32_32x32x16_bf16 v[80:95], v[140:143], v[132:135], v[80:95]
  ds_read_b64_tr_b16 v[140:141], v8 offset:12288
  ds_read_b64_tr_b16 v[142:143], v8 offset:12800
  v_mfma_f32_32x32x16_bf16 v[96:111], v[144:147], v[128:131], v[96:111]
  ds_read_b128 v[128:131], v4 offset:32768
  v_mfma_f32_32x32x16_bf16 v[112:127], v[144:147], v[132:135], v[112:127]
  ds_read_b64_tr_b16 v[144:145], v8 offset:20480
  ds_read_b64_tr_b16 v[146:147], v8 offset:20992
  ds_read_b128 v[132:135], v4 offset:36864
  ds_read_b64 v[14:15], v11 offset:512
  s_waitcnt lgkmcnt(13)
  v_mfma_f32_32x32x16_bf16 v[32:47], v[156:159], v[148:151], v[32:47]
  s_waitcnt lgkmcnt(10)
  v_mfma_f32_32x32x16_bf16 v[48:63], v[156:159], v[152:155], v[48:63]
  ds_read_b64_tr_b16 v[156:157], v8 offset:5120
  ds_read_b64_tr_b16 v[158:159], v8 offset:5632
  v_mfma_f32_32x32x16_bf16 v[64:79], v[160:163], v[148:151], v[64:79]
  v_mfma_f32_32x32x16_bf16 v[80:95], v[160:163], v[152:155], v[80:95]
  ds_read_b64_tr_b16 v[160:161], v8 offset:13312
  ds_read_b64_tr_b16 v[162:163], v8 offset:13824
  v_mfma_f32_32x32x16_bf16 v[96:111], v[164:167], v[148:151], v[96:111]
  ds_read_b128 v[148:151], v5 offset:32768
  v_mfma_f32_32x32x16_bf16 v[112:127], v[164:167], v[152:155], v[112:127]
  ds_read_b64_tr_b16 v[164:165], v8 offset:21504
  ds_read_b64_tr_b16 v[166:167], v8 offset:22016
  ds_read_b128 v[152:155], v5 offset:36864
  s_waitcnt lgkmcnt(12)
  v_mfma_f32_32x32x16_bf16 v[32:47], v[136:139], v[128:131], v[32:47]
  s_waitcnt lgkmcnt(9)
  v_mfma_f32_32x32x16_bf16 v[48:63], v[136:139], v[132:135], v[48:63]
  v_mfma_f32_32x32x16_bf16 v[64:79], v[140:143], v[128:131], v[64:79]
  s_waitcnt lgkmcnt(0)
  s_barrier
  ds_read_b64_tr_b16 v[136:137], v6 offset:32768
  ds_read_b64_tr_b16 v[138:139], v6 offset:33280
  v_mfma_f32_32x32x16_bf16 v[80:95], v[140:143], v[132:135], v[80:95]
  ds_read_b64_tr_b16 v[140:141], v6 offset:40960
  ds_read_b64_tr_b16 v[142:143], v6 offset:41472
  v_mfma_f32_32x32x16_bf16 v[96:111], v[144:147], v[128:131], v[96:111]
  ds_read_b128 v[128:131], v2 offset:0
  v_mfma_f32_32x32x16_bf16 v[112:127], v[144:147], v[132:135], v[112:127]
  ds_read_b64_tr_b16 v[144:145], v6 offset:49152
  ds_read_b64_tr_b16 v[146:147], v6 offset:49664
  ds_read_b128 v[132:135], v2 offset:4096
  v_mfma_f32_32x32x16_bf16 v[32:47], v[156:159], v[148:151], v[32:47]
  v_lshlrev_b32 v28, 16, v12
  v_mfma_f32_32x32x16_bf16 v[48:63], v[156:159], v[152:155], v[48:63]
  ds_read_b64_tr_b16 v[156:157], v6 offset:33792
  ds_read_b64_tr_b16 v[158:159], v6 offset:34304
  v_lshlrev_b32 v29, 16, v14
  v_fmac_f32 v16, v28, v29
  v_mfma_f32_32x32x16_bf16 v[64:79], v[160:163], v[148:151], v[64:79]
  v_and_b32 v28, 0xffff0000, v12
  v_and_b32 v29, 0xffff0000, v14
  v_mfma_f32_32x32x16_bf16 v[80:95], v[160:163], v[152:155], v[80:95]
  ds_read_b64_tr_b16 v[160:161], v6 offset:41984
  ds_read_b64_tr_b16 v[162:163], v6 offset:42496
  v_fmac_f32 v16, v28, v29
  v_lshlrev_b32 v28, 16, v13
  v_mfma_f32_32x32x16_bf16 v[96:111], v[164:167], v[148:151], v[96:111]
  ds_read_b128 v[148:151], v3 offset:0
  v_lshlrev_b32 v29, 16, v15
  v_fmac_f32 v16, v28, v29
  v_mfma_f32_32x32x16_bf16 v[112:127], v[164:167], v[152:155], v[112:127]
  ds_read_b64_tr_b16 v[164:165], v6 offset:50176
  ds_read_b64_tr_b16 v[166:167], v6 offset:50688
  ds_read_b128 v[152:155], v3 offset:4096
  v_and_b32 v28, 0xffff0000, v13
  v_and_b32 v29, 0xffff0000, v15
  v_fmac_f32 v16, v28, v29
  s_waitcnt lgkmcnt(11)
  v_mfma_f32_32x32x16_bf16 v[32:47], v[136:139], v[128:131], v[32:47]
  s_waitcnt lgkmcnt(8)
  v_mfma_f32_32x32x16_bf16 v[48:63], v[136:139], v[132:135], v[48:63]
  ds_read_b64_tr_b16 v[136:137], v6 offset:36864
  ds_read_b64_tr_b16 v[138:139], v6 offset:37376
  v_mfma_f32_32x32x16_bf16 v[64:79], v[140:143], v[128:131], v[64:79]
  ds_read_b64 v[12:13], v10 offset:0
  v_mfma_f32_32x32x16_bf16 v[80:95], v[140:143], v[132:135], v[80:95]
  ds_read_b64_tr_b16 v[140:141], v6 offset:45056
  ds_read_b64_tr_b16 v[142:143], v6 offset:45568
  v_mfma_f32_32x32x16_bf16 v[96:111], v[144:147], v[128:131], v[96:111]
  ds_read_b128 v[128:131], v4 offset:0
  v_mfma_f32_32x32x16_bf16 v[112:127], v[144:147], v[132:135], v[112:127]
  ds_read_b64_tr_b16 v[144:145], v6 offset:53248
  ds_read_b64_tr_b16 v[146:147], v6 offset:53760
  ds_read_b128 v[132:135], v4 offset:4096
  ds_read_b64 v[14:15], v11 offset:640
  s_waitcnt lgkmcnt(13)
  v_mfma_f32_32x32x16_bf16 v[32:47], v[156:159], v[148:151], v[32:47]
  s_waitcnt lgkmcnt(10)
  v_mfma_f32_32x32x16_bf16 v[48:63], v[156:159], v[152:155], v[48:63]
  ds_read_b64_tr_b16 v[156:157], v6 offset:37888
  ds_read_b64_tr_b16 v[158:159], v6 offset:38400
  v_mfma_f32_32x32x16_bf16 v[64:79], v[160:163], v[148:151], v[64:79]
  v_mfma_f32_32x32x16_bf16 v[80:95], v[160:163], v[152:155], v[80:95]
  ds_read_b64_tr_b16 v[160:161], v6 offset:46080
  ds_read_b64_tr_b16 v[162:163], v6 offset:46592
  v_mfma_f32_32x32x16_bf16 v[96:111], v[164:167], v[148:151], v[96:111]
  ds_read_b128 v[148:151], v5 offset:0
  v_mfma_f32_32x32x16_bf16 v[112:127], v[164:167], v[152:155], v[112:127]
  ds_read_b64_tr_b16 v[164:165], v6 offset:54272
  ds_read_b64_tr_b16 v[166:167], v6 offset:54784
  ds_read_b128 v[152:155], v5 offset:4096
  s_waitcnt lgkmcnt(12)
  v_mfma_f32_32x32x16_bf16 v[32:47], v[136:139], v[128:131], v[32:47]
  s_waitcnt lgkmcnt(9)
  v_mfma_f32_32x32x16_bf16 v[48:63], v[136:139], v[132:135], v[48:63]
  v_mfma_f32_32x32x16_bf16 v[64:79], v[140:143], v[128:131], v[64:79]
  s_waitcnt lgkmcnt(0)
  s_barrier
  ds_read_b64_tr_b16 v[136:137], v7 offset:40960
  ds_read_b64_tr_b16 v[138:139], v7 offset:41472
  v_mfma_f32_32x32x16_bf16 v[80:95], v[140:143], v[132:135], v[80:95]
  ds_read_b64_tr_b16 v[140:141], v7 offset:49152
  ds_read_b64_tr_b16 v[142:143], v7 offset:49664
  v_mfma_f32_32x32x16_bf16 v[96:111], v[144:147], v[128:131], v[96:111]
  ds_read_b128 v[128:131], v2 offset:16384
  v_mfma_f32_32x32x16_bf16 v[112:127], v[144:147], v[132:135], v[112:127]
  ds_read_b64_tr_b16 v[144:145], v7 offset:57344
  ds_read_b64_tr_b16 v[146:147], v7 offset:57856
  ds_read_b128 v[132:135], v2 offset:20480
  v_mfma_f32_32x32x16_bf16 v[32:47], v[156:159], v[148:151], v[32:47]
  v_lshlrev_b32 v28, 16, v12
  v_mfma_f32_32x32x16_bf16 v[48:63], v[156:159], v[152:155], v[48:63]
  ds_read_b64_tr_b16 v[156:157], v7 offset:41984
  ds_read_b64_tr_b16 v[158:159], v7 offset:42496
  v_lshlrev_b32 v29, 16, v14
  v_fmac_f32 v16, v28, v29
  v_mfma_f32_32x32x16_bf16 v[64:79], v[160:163], v[148:151], v[64:79]
  v_and_b32 v28, 0xffff0000, v12
  v_and_b32 v29, 0xffff0000, v14
  v_mfma_f32_32x32x16_bf16 v[80:95], v[160:163], v[152:155], v[80:95]
  ds_read_b64_tr_b16 v[160:161], v7 offset:50176
  ds_read_b64_tr_b16 v[162:163], v7 offset:50688
  v_fmac_f32 v16, v28, v29
  v_lshlrev_b32 v28, 16, v13
  v_mfma_f32_32x32x16_bf16 v[96:111], v[164:167], v[148:151], v[96:111]
  ds_read_b128 v[148:151], v3 offset:16384
  v_lshlrev_b32 v29, 16, v15
  v_fmac_f32 v16, v28, v29
  v_mfma_f32_32x32x16_bf16 v[112:127], v[164:167], v[152:155], v[112:127]
  ds_read_b64_tr_b16 v[164:165], v7 offset:58368
  ds_read_b64_tr_b16 v[166:167], v7 offset:58880
  ds_read_b128 v[152:155], v3 offset:20480
  v_and_b32 v28, 0xffff0000, v13
  v_and_b32 v29, 0xffff0000, v15
  v_fmac_f32 v16, v28, v29
  s_waitcnt lgkmcnt(11)
  v_mfma_f32_32x32x16_bf16 v[32:47], v[136:139], v[128:131], v[32:47]
  s_waitcnt lgkmcnt(8)
  v_mfma_f32_32x32x16_bf16 v[48:63], v[136:139], v[132:135], v[48:63]
  ds_read_b64_tr_b16 v[136:137], v7 offset:45056
  ds_read_b64_tr_b16 v[138:139], v7 offset:45568
  v_mfma_f32_32x32x16_bf16 v[64:79], v[140:143], v[128:131], v[64:79]
  ds_read_b64 v[12:13], v10 offset:16384
  v_mfma_f32_32x32x16_bf16 v[80:95], v[140:143], v[132:135], v[80:95]
  ds_read_b64_tr_b16 v[140:141], v7 offset:53248
  ds_read_b64_tr_b16 v[142:143], v7 offset:53760
  v_mfma_f32_32x32x16_bf16 v[96:111], v[144:147], v[128:131], v[96:111]
  ds_read_b128 v[128:131], v4 offset:16384
  v_mfma_f32_32x32x16_bf16 v[112:127], v[144:147], v[132:135], v[112:127]
  ds_read_b64_tr_b16 v[144:145], v7 offset:61440
  ds_read_b64_tr_b16 v[146:147], v7 offset:61952
  ds_read_b128 v[132:135], v4 offset:20480
  ds_read_b64 v[14:15], v11 offset:768
  s_waitcnt lgkmcnt(13)
  v_mfma_f32_32x32x16_bf16 v[32:47], v[156:159], v[148:151], v[32:47]
  s_waitcnt lgkmcnt(10)
  v_mfma_f32_32x32x16_bf16 v[48:63], v[156:159], v[152:155], v[48:63]
  ds_read_b64_tr_b16 v[156:157], v7 offset:46080
  ds_read_b64_tr_b16 v[158:159], v7 offset:46592
  v_mfma_f32_32x32x16_bf16 v[64:79], v[160:163], v[148:151], v[64:79]
  v_mfma_f32_32x32x16_bf16 v[80:95], v[160:163], v[152:155], v[80:95]
  ds_read_b64_tr_b16 v[160:161], v7 offset:54272
  ds_read_b64_tr_b16 v[162:163], v7 offset:54784
  v_mfma_f32_32x32x16_bf16 v[96:111], v[164:167], v[148:151], v[96:111]
  ds_read_b128 v[148:151], v5 offset:16384
  v_mfma_f32_32x32x16_bf16 v[112:127], v[164:167], v[152:155], v[112:127]
  ds_read_b64_tr_b16 v[164:165], v7 offset:62464
  ds_read_b64_tr_b16 v[166:167], v7 offset:62976
  ds_read_b128 v[152:155], v5 offset:20480
  s_waitcnt lgkmcnt(12)
  v_mfma_f32_32x32x16_bf16 v[32:47], v[136:139], v[128:131], v[32:47]
  s_waitcnt lgkmcnt(9)
  v_mfma_f32_32x32x16_bf16 v[48:63], v[136:139], v[132:135], v[48:63]
  v_mfma_f32_32x32x16_bf16 v[64:79], v[140:143], v[128:131], v[64:79]
  s_waitcnt lgkmcnt(0)
  s_barrier
  ds_read_b64_tr_b16 v[136:137], v8 offset:0
  ds_read_b64_tr_b16 v[138:139], v8 offset:512
  v_mfma_f32_32x32x16_bf16 v[80:95], v[140:143], v[132:135], v[80:95]
  ds_read_b64_tr_b16 v[140:141], v8 offset:8192
  ds_read_b64_tr_b16 v[142:143], v8 offset:8704
  v_mfma_f32_32x32x16_bf16 v[96:111], v[144:147], v[128:131], v[96:111]
  ds_read_b128 v[128:131], v2 offset:32768
  v_mfma_f32_32x32x16_bf16 v[112:127], v[144:147], v[132:135], v[112:127]
  ds_read_b64_tr_b16 v[144:145], v8 offset:16384
  ds_read_b64_tr_b16 v[146:147], v8 offset:16896
  ds_read_b128 v[132:135], v2 offset:36864
  v_mfma_f32_32x32x16_bf16 v[32:47], v[156:159], v[148:151], v[32:47]
  v_lshlrev_b32 v28, 16, v12
  v_mfma_f32_32x32x16_bf16 v[48:63], v[156:159], v[152:155], v[48:63]
  ds_read_b64_tr_b16 v[156:157], v8 offset:1024
  ds_read_b64_tr_b16 v[158:159], v8 offset:1536
  v_lshlrev_b32 v29, 16, v14
  v_fmac_f32 v16, v28, v29
  v_mfma_f32_32x32x16_bf16 v[64:79], v[160:163], v[148:151], v[64:79]
  v_and_b32 v28, 0xffff0000, v12
  v_and_b32 v29, 0xffff0000, v14
  v_mfma_f32_32x32x16_bf16 v[80:95], v[160:163], v[152:155], v[80:95]
  ds_read_b64_tr_b16 v[160:161], v8 offset:9216
  ds_read_b64_tr_b16 v[162:163], v8 offset:9728
  v_fmac_f32 v16, v28, v29
  v_lshlrev_b32 v28, 16, v13
  v_mfma_f32_32x32x16_bf16 v[96:111], v[164:167], v[148:151], v[96:111]
  ds_read_b128 v[148:151], v3 offset:32768
  v_lshlrev_b32 v29, 16, v15
  v_fmac_f32 v16, v28, v29
  v_mfma_f32_32x32x16_bf16 v[112:127], v[164:167], v[152:155], v[112:127]
  ds_read_b64_tr_b16 v[164:165], v8 offset:17408
  ds_read_b64_tr_b16 v[166:167], v8 offset:17920
  ds_read_b128 v[152:155], v3 offset:36864
  v_and_b32 v28, 0xffff0000, v13
  v_and_b32 v29, 0xffff0000, v15
  v_fmac_f32 v16, v28, v29
  s_waitcnt lgkmcnt(11)
  v_mfma_f32_32x32x16_bf16 v[32:47], v[136:139], v[128:131], v[32:47]
  s_waitcnt lgkmcnt(8)
  v_mfma_f32_32x32x16_bf16 v[48:63], v[136:139], v[132:135], v[48:63]
  ds_read_b64_tr_b16 v[136:137], v8 offset:4096
  ds_read_b64_tr_b16 v[138:139], v8 offset:4608
  v_mfma_f32_32x32x16_bf16 v[64:79], v[140:143], v[128:131], v[64:79]
  ds_read_b64 v[12:13], v10 offset:32768
  v_mfma_f32_32x32x16_bf16 v[80:95], v[140:143], v[132:135], v[80:95]
  ds_read_b64_tr_b16 v[140:141], v8 offset:12288
  ds_read_b64_tr_b16 v[142:143], v8 offset:12800
  v_mfma_f32_32x32x16_bf16 v[96:111], v[144:147], v[128:131], v[96:111]
  ds_read_b128 v[128:131], v4 offset:32768
  v_mfma_f32_32x32x16_bf16 v[112:127], v[144:147], v[132:135], v[112:127]
  ds_read_b64_tr_b16 v[144:145], v8 offset:20480
  ds_read_b64_tr_b16 v[146:147], v8 offset:20992
  ds_read_b128 v[132:135], v4 offset:36864
  ds_read_b64 v[14:15], v11 offset:896
  s_waitcnt lgkmcnt(13)
  v_mfma_f32_32x32x16_bf16 v[32:47], v[156:159], v[148:151], v[32:47]
  s_waitcnt lgkmcnt(10)
  v_mfma_f32_32x32x16_bf16 v[48:63], v[156:159], v[152:155], v[48:63]
  ds_read_b64_tr_b16 v[156:157], v8 offset:5120
  ds_read_b64_tr_b16 v[158:159], v8 offset:5632
  v_mfma_f32_32x32x16_bf16 v[64:79], v[160:163], v[148:151], v[64:79]
  v_mfma_f32_32x32x16_bf16 v[80:95], v[160:163], v[152:155], v[80:95]
  ds_read_b64_tr_b16 v[160:161], v8 offset:13312
  ds_read_b64_tr_b16 v[162:163], v8 offset:13824
  v_mfma_f32_32x32x16_bf16 v[96:111], v[164:167], v[148:151], v[96:111]
  ds_read_b128 v[148:151], v5 offset:32768
  v_mfma_f32_32x32x16_bf16 v[112:127], v[164:167], v[152:155], v[112:127]
  ds_read_b64_tr_b16 v[164:165], v8 offset:21504
  ds_read_b64_tr_b16 v[166:167], v8 offset:22016
  ds_read_b128 v[152:155], v5 offset:36864
  s_waitcnt lgkmcnt(12)
  v_mfma_f32_32x32x16_bf16 v[32:47], v[136:139], v[128:131], v[32:47]
  s_waitcnt lgkmcnt(8)
  v_lshlrev_b32 v28, 16, v12
  v_mfma_f32_32x32x16_bf16 v[48:63], v[136:139], v[132:135], v[48:63]
  v_lshlrev_b32 v29, 16, v14
  v_fmac_f32 v16, v28, v29
  v_mfma_f32_32x32x16_bf16 v[64:79], v[140:143], v[128:131], v[64:79]
  s_waitcnt lgkmcnt(0)
  s_barrier
  v_and_b32 v28, 0xffff0000, v12
  v_and_b32 v29, 0xffff0000, v14
  v_mfma_f32_32x32x16_bf16 v[80:95], v[140:143], v[132:135], v[80:95]
  v_fmac_f32 v16, v28, v29
  v_lshlrev_b32 v28, 16, v13
  v_mfma_f32_32x32x16_bf16 v[96:111], v[144:147], v[128:131], v[96:111]
  v_lshlrev_b32 v29, 16, v15
  v_fmac_f32 v16, v28, v29
  v_mfma_f32_32x32x16_bf16 v[112:127], v[144:147], v[132:135], v[112:127]
  v_and_b32 v28, 0xffff0000, v13
  v_and_b32 v29, 0xffff0000, v15
  v_fmac_f32_e64 v16, v28, v29
  v_mfma_f32_32x32x16_bf16 v[32:47], v[156:159], v[148:151], v[32:47]
  s_nop 1
  v_add_f32_dpp v16, v16, v16 row_ror:1 row_mask:0xf bank_mask:0xf
  v_mfma_f32_32x32x16_bf16 v[48:63], v[156:159], v[152:155], v[48:63]
  s_nop 1
  v_add_f32_dpp v16, v16, v16 row_ror:2 row_mask:0xf bank_mask:0xf
  v_mfma_f32_32x32x16_bf16 v[64:79], v[160:163], v[148:151], v[64:79]
  s_nop 1
  v_add_f32_dpp v16, v16, v16 row_ror:4 row_mask:0xf bank_mask:0xf
  s_nop 1
  v_mfma_f32_32x32x16_bf16 v[80:95], v[160:163], v[152:155], v[80:95]
  v_add_f32_dpp v16, v16, v16 row_ror:8 row_mask:0xf bank_mask:0xf
  v_mul_f32 v16, 0xbfb8aa3b, v16
  v_mfma_f32_32x32x16_bf16 v[96:111], v[164:167], v[148:151], v[96:111]
  v_exp_f32 v16, v16
  v_lshrrev_b32 v28, 2, v0
  v_mfma_f32_32x32x16_bf16 v[112:127], v[164:167], v[152:155], v[112:127]
  v_add_f32 v16, 1.0, v16
  v_rcp_f32 v16, v16
  s_mov_b32 exec_lo, 0x10001
  s_mov_b32 exec_hi, 0x10001
  buffer_store_dword v16, v28, s[48:51], s70 offen sc1
  s_mov_b64 exec, -1
  v_pk_mul_f32 v[184:185], v[32:33], v[32:33]
  v_pk_mul_f32 v[186:187], v[34:35], v[34:35]
  v_pk_mul_f32 v[188:189], v[36:37], v[36:37]
  v_pk_mul_f32 v[190:191], v[38:39], v[38:39]
  v_pk_mul_f32 v[192:193], v[40:41], v[40:41]
  v_pk_mul_f32 v[194:195], v[42:43], v[42:43]
  v_pk_mul_f32 v[196:197], v[44:45], v[44:45]
  v_pk_mul_f32 v[198:199], v[46:47], v[46:47]
  v_pk_fma_f32 v[184:185], v[184:185], s[12:13], v[18:19] op_sel:[0,1,1] op_sel_hi:[1,1,1]
  v_pk_fma_f32 v[186:187], v[186:187], s[12:13], v[18:19] op_sel:[0,1,1] op_sel_hi:[1,1,1]
  v_pk_fma_f32 v[188:189], v[188:189], s[12:13], v[18:19] op_sel:[0,1,1] op_sel_hi:[1,1,1]
  v_pk_fma_f32 v[190:191], v[190:191], s[12:13], v[18:19] op_sel:[0,1,1] op_sel_hi:[1,1,1]
  v_pk_fma_f32 v[192:193], v[192:193], s[12:13], v[18:19] op_sel:[0,1,1] op_sel_hi:[1,1,1]
  v_pk_fma_f32 v[194:195], v[194:195], s[12:13], v[18:19] op_sel:[0,1,1] op_sel_hi:[1,1,1]
  v_pk_fma_f32 v[196:197], v[196:197], s[12:13], v[18:19] op_sel:[0,1,1] op_sel_hi:[1,1,1]
  v_pk_fma_f32 v[198:199], v[198:199], s[12:13], v[18:19] op_sel:[0,1,1] op_sel_hi:[1,1,1]
  v_pk_mul_f32 v[184:185], v[184:185], v[32:33]
  v_pk_mul_f32 v[186:187], v[186:187], v[34:35]
  v_pk_mul_f32 v[188:189], v[188:189], v[36:37]
  v_pk_mul_f32 v[190:191], v[190:191], v[38:39]
  v_pk_mul_f32 v[192:193], v[192:193], v[40:41]
  v_pk_mul_f32 v[194:195], v[194:195], v[42:43]
  v_pk_mul_f32 v[196:197], v[196:197], v[44:45]
  v_pk_mul_f32 v[198:199], v[198:199], v[46:47]
  v_exp_f32 v184, v184
  v_exp_f32 v185, v185
  v_exp_f32 v186, v186
  v_exp_f32 v187, v187
  v_exp_f32 v188, v188
  v_exp_f32 v189, v189
  v_exp_f32 v190, v190
  v_exp_f32 v191, v191
  v_exp_f32 v192, v192
  v_exp_f32 v193, v193
  v_exp_f32 v194, v194
  v_exp_f32 v195, v195
  v_exp_f32 v196, v196
  v_exp_f32 v197, v197
  v_exp_f32 v198, v198
  v_exp_f32_e64 v199, v199
  v_pk_add_f32 v[184:185], v[184:185], 1.0 op_sel_hi:[1,0]
  v_pk_add_f32 v[186:187], v[186:187], 1.0 op_sel_hi:[1,0]
  v_pk_add_f32 v[188:189], v[188:189], 1.0 op_sel_hi:[1,0]
  v_pk_add_f32 v[190:191], v[190:191], 1.0 op_sel_hi:[1,0]
  v_pk_add_f32 v[192:193], v[192:193], 1.0 op_sel_hi:[1,0]
  v_pk_add_f32 v[194:195], v[194:195], 1.0 op_sel_hi:[1,0]
  v_pk_add_f32 v[196:197], v[196:197], 1.0 op_sel_hi:[1,0]
  v_pk_add_f32 v[198:199], v[198:199], 1.0 op_sel_hi:[1,0]
  v_rcp_f32 v184, v184
  v_rcp_f32 v185, v185
  v_rcp_f32 v186, v186
  v_rcp_f32 v187, v187
  v_rcp_f32 v188, v188
  v_rcp_f32 v189, v189
  v_rcp_f32 v190, v190
  v_rcp_f32 v191, v191
  v_rcp_f32 v192, v192
  v_rcp_f32 v193, v193
  v_rcp_f32 v194, v194
  v_rcp_f32 v195, v195
  v_rcp_f32 v196, v196
  v_rcp_f32 v197, v197
  v_rcp_f32 v198, v198
  v_rcp_f32 v199, v199
  v_pk_mul_f32 v[184:185], v[184:185], v[32:33]
  v_pk_mul_f32 v[186:187], v[186:187], v[34:35]
  v_pk_mul_f32 v[188:189], v[188:189], v[36:37]
  v_pk_mul_f32 v[190:191], v[190:191], v[38:39]
  v_pk_mul_f32 v[192:193], v[192:193], v[40:41]
  v_pk_mul_f32 v[194:195], v[194:195], v[42:43]
  v_pk_mul_f32 v[196:197], v[196:197], v[44:45]
  v_pk_mul_f32 v[198:199], v[198:199], v[46:47]
  v_cvt_pk_bf16_f32 v32, v184, v185
  v_cvt_pk_bf16_f32 v33, v186, v187
  v_cvt_pk_bf16_f32 v34, v188, v189
  v_cvt_pk_bf16_f32 v35, v190, v191
  v_cvt_pk_bf16_f32 v36, v192, v193
  v_cvt_pk_bf16_f32 v37, v194, v195
  v_cvt_pk_bf16_f32 v38, v196, v197
  v_cvt_pk_bf16_f32 v39, v198, v199
  s_add_u32 s72, s31, 0
  buffer_store_dwordx4 v[32:35], v1, s[48:51], s72 offen offset:0 sc1
  buffer_store_dwordx4 v[36:39], v1, s[48:51], s72 offen offset:1024 sc1
  v_pk_mul_f32 v[184:185], v[48:49], v[48:49]
  v_pk_mul_f32 v[186:187], v[50:51], v[50:51]
  v_pk_mul_f32 v[188:189], v[52:53], v[52:53]
  v_pk_mul_f32 v[190:191], v[54:55], v[54:55]
  v_pk_mul_f32 v[192:193], v[56:57], v[56:57]
  v_pk_mul_f32 v[194:195], v[58:59], v[58:59]
  v_pk_mul_f32 v[196:197], v[60:61], v[60:61]
  v_pk_mul_f32 v[198:199], v[62:63], v[62:63]
  v_pk_fma_f32 v[184:185], v[184:185], s[12:13], v[18:19] op_sel:[0,1,1] op_sel_hi:[1,1,1]
  v_pk_fma_f32 v[186:187], v[186:187], s[12:13], v[18:19] op_sel:[0,1,1] op_sel_hi:[1,1,1]
  v_pk_fma_f32 v[188:189], v[188:189], s[12:13], v[18:19] op_sel:[0,1,1] op_sel_hi:[1,1,1]
  v_pk_fma_f32 v[190:191], v[190:191], s[12:13], v[18:19] op_sel:[0,1,1] op_sel_hi:[1,1,1]
  v_pk_fma_f32 v[192:193], v[192:193], s[12:13], v[18:19] op_sel:[0,1,1] op_sel_hi:[1,1,1]
  v_pk_fma_f32 v[194:195], v[194:195], s[12:13], v[18:19] op_sel:[0,1,1] op_sel_hi:[1,1,1]
  v_pk_fma_f32 v[196:197], v[196:197], s[12:13], v[18:19] op_sel:[0,1,1] op_sel_hi:[1,1,1]
  v_pk_fma_f32 v[198:199], v[198:199], s[12:13], v[18:19] op_sel:[0,1,1] op_sel_hi:[1,1,1]
  v_pk_mul_f32 v[184:185], v[184:185], v[48:49]
  v_pk_mul_f32 v[186:187], v[186:187], v[50:51]
  v_pk_mul_f32 v[188:189], v[188:189], v[52:53]
  v_pk_mul_f32 v[190:191], v[190:191], v[54:55]
  v_pk_mul_f32 v[192:193], v[192:193], v[56:57]
  v_pk_mul_f32 v[194:195], v[194:195], v[58:59]
  v_pk_mul_f32 v[196:197], v[196:197], v[60:61]
  v_pk_mul_f32 v[198:199], v[198:199], v[62:63]
  v_exp_f32 v184, v184
  v_exp_f32 v185, v185
  v_exp_f32 v186, v186
  v_exp_f32 v187, v187
  v_exp_f32 v188, v188
  v_exp_f32 v189, v189
  v_exp_f32 v190, v190
  v_exp_f32 v191, v191
  v_exp_f32 v192, v192
  v_exp_f32 v193, v193
  v_exp_f32 v194, v194
  v_exp_f32 v195, v195
  v_exp_f32 v196, v196
  v_exp_f32 v197, v197
  v_exp_f32 v198, v198
  v_exp_f32_e64 v199, v199
  v_pk_add_f32 v[184:185], v[184:185], 1.0 op_sel_hi:[1,0]
  v_pk_add_f32 v[186:187], v[186:187], 1.0 op_sel_hi:[1,0]
  v_pk_add_f32 v[188:189], v[188:189], 1.0 op_sel_hi:[1,0]
  v_pk_add_f32 v[190:191], v[190:191], 1.0 op_sel_hi:[1,0]
  v_pk_add_f32 v[192:193], v[192:193], 1.0 op_sel_hi:[1,0]
  v_pk_add_f32 v[194:195], v[194:195], 1.0 op_sel_hi:[1,0]
  v_pk_add_f32 v[196:197], v[196:197], 1.0 op_sel_hi:[1,0]
  v_pk_add_f32 v[198:199], v[198:199], 1.0 op_sel_hi:[1,0]
  v_rcp_f32 v184, v184
  v_rcp_f32 v185, v185
  v_rcp_f32 v186, v186
  v_rcp_f32 v187, v187
  v_rcp_f32 v188, v188
  v_rcp_f32 v189, v189
  v_rcp_f32 v190, v190
  v_rcp_f32 v191, v191
  v_rcp_f32 v192, v192
  v_rcp_f32 v193, v193
  v_rcp_f32 v194, v194
  v_rcp_f32 v195, v195
  v_rcp_f32 v196, v196
  v_rcp_f32 v197, v197
  v_rcp_f32 v198, v198
  v_rcp_f32 v199, v199
  v_pk_mul_f32 v[184:185], v[184:185], v[48:49]
  v_pk_mul_f32 v[186:187], v[186:187], v[50:51]
  v_pk_mul_f32 v[188:189], v[188:189], v[52:53]
  v_pk_mul_f32 v[190:191], v[190:191], v[54:55]
  v_pk_mul_f32 v[192:193], v[192:193], v[56:57]
  v_pk_mul_f32 v[194:195], v[194:195], v[58:59]
  v_pk_mul_f32 v[196:197], v[196:197], v[60:61]
  v_pk_mul_f32 v[198:199], v[198:199], v[62:63]
  v_cvt_pk_bf16_f32 v48, v184, v185
  v_cvt_pk_bf16_f32 v49, v186, v187
  v_cvt_pk_bf16_f32 v50, v188, v189
  v_cvt_pk_bf16_f32 v51, v190, v191
  v_cvt_pk_bf16_f32 v52, v192, v193
  v_cvt_pk_bf16_f32 v53, v194, v195
  v_cvt_pk_bf16_f32 v54, v196, v197
  v_cvt_pk_bf16_f32 v55, v198, v199
  s_add_u32 s72, s31, 122880
  buffer_store_dwordx4 v[48:51], v1, s[48:51], s72 offen offset:0 sc1
  buffer_store_dwordx4 v[52:55], v1, s[48:51], s72 offen offset:1024 sc1
  v_pk_mul_f32 v[184:185], v[64:65], v[64:65]
  v_pk_mul_f32 v[186:187], v[66:67], v[66:67]
  v_pk_mul_f32 v[188:189], v[68:69], v[68:69]
  v_pk_mul_f32 v[190:191], v[70:71], v[70:71]
  v_pk_mul_f32 v[192:193], v[72:73], v[72:73]
  v_pk_mul_f32 v[194:195], v[74:75], v[74:75]
  v_pk_mul_f32 v[196:197], v[76:77], v[76:77]
  v_pk_mul_f32 v[198:199], v[78:79], v[78:79]
  v_pk_fma_f32 v[184:185], v[184:185], s[12:13], v[18:19] op_sel:[0,1,1] op_sel_hi:[1,1,1]
  v_pk_fma_f32 v[186:187], v[186:187], s[12:13], v[18:19] op_sel:[0,1,1] op_sel_hi:[1,1,1]
  v_pk_fma_f32 v[188:189], v[188:189], s[12:13], v[18:19] op_sel:[0,1,1] op_sel_hi:[1,1,1]
  v_pk_fma_f32 v[190:191], v[190:191], s[12:13], v[18:19] op_sel:[0,1,1] op_sel_hi:[1,1,1]
  v_pk_fma_f32 v[192:193], v[192:193], s[12:13], v[18:19] op_sel:[0,1,1] op_sel_hi:[1,1,1]
  v_pk_fma_f32 v[194:195], v[194:195], s[12:13], v[18:19] op_sel:[0,1,1] op_sel_hi:[1,1,1]
  v_pk_fma_f32 v[196:197], v[196:197], s[12:13], v[18:19] op_sel:[0,1,1] op_sel_hi:[1,1,1]
  v_pk_fma_f32 v[198:199], v[198:199], s[12:13], v[18:19] op_sel:[0,1,1] op_sel_hi:[1,1,1]
  v_pk_mul_f32 v[184:185], v[184:185], v[64:65]
  v_pk_mul_f32 v[186:187], v[186:187], v[66:67]
  v_pk_mul_f32 v[188:189], v[188:189], v[68:69]
  v_pk_mul_f32 v[190:191], v[190:191], v[70:71]
  v_pk_mul_f32 v[192:193], v[192:193], v[72:73]
  v_pk_mul_f32 v[194:195], v[194:195], v[74:75]
  v_pk_mul_f32 v[196:197], v[196:197], v[76:77]
  v_pk_mul_f32 v[198:199], v[198:199], v[78:79]
  v_exp_f32 v184, v184
  v_exp_f32 v185, v185
  v_exp_f32 v186, v186
  v_exp_f32 v187, v187
  v_exp_f32 v188, v188
  v_exp_f32 v189, v189
  v_exp_f32 v190, v190
  v_exp_f32 v191, v191
  v_exp_f32 v192, v192
  v_exp_f32 v193, v193
  v_exp_f32 v194, v194
  v_exp_f32 v195, v195
  v_exp_f32 v196, v196
  v_exp_f32 v197, v197
  v_exp_f32 v198, v198
  v_exp_f32 v199, v199
  v_pk_add_f32 v[184:185], v[184:185], 1.0 op_sel_hi:[1,0]
  v_pk_add_f32 v[186:187], v[186:187], 1.0 op_sel_hi:[1,0]
  v_pk_add_f32 v[188:189], v[188:189], 1.0 op_sel_hi:[1,0]
  v_pk_add_f32 v[190:191], v[190:191], 1.0 op_sel_hi:[1,0]
  v_pk_add_f32 v[192:193], v[192:193], 1.0 op_sel_hi:[1,0]
  v_pk_add_f32 v[194:195], v[194:195], 1.0 op_sel_hi:[1,0]
  v_pk_add_f32 v[196:197], v[196:197], 1.0 op_sel_hi:[1,0]
  v_pk_add_f32 v[198:199], v[198:199], 1.0 op_sel_hi:[1,0]
  v_rcp_f32 v184, v184
  v_rcp_f32 v185, v185
  v_rcp_f32 v186, v186
  v_rcp_f32 v187, v187
  v_rcp_f32 v188, v188
  v_rcp_f32 v189, v189
  v_rcp_f32 v190, v190
  v_rcp_f32 v191, v191
  v_rcp_f32 v192, v192
  v_rcp_f32 v193, v193
  v_rcp_f32 v194, v194
  v_rcp_f32 v195, v195
  v_rcp_f32 v196, v196
  v_rcp_f32 v197, v197
  v_rcp_f32 v198, v198
  v_rcp_f32 v199, v199
  v_pk_mul_f32 v[184:185], v[184:185], v[64:65]
  v_pk_mul_f32 v[186:187], v[186:187], v[66:67]
  v_pk_mul_f32 v[188:189], v[188:189], v[68:69]
  v_pk_mul_f32 v[190:191], v[190:191], v[70:71]
  v_pk_mul_f32 v[192:193], v[192:193], v[72:73]
  v_pk_mul_f32 v[194:195], v[194:195], v[74:75]
  v_pk_mul_f32 v[196:197], v[196:197], v[76:77]
  v_pk_mul_f32 v[198:199], v[198:199], v[78:79]
  v_cvt_pk_bf16_f32 v64, v184, v185
  v_cvt_pk_bf16_f32 v65, v186, v187
  v_cvt_pk_bf16_f32 v66, v188, v189
  v_cvt_pk_bf16_f32 v67, v190, v191
  v_cvt_pk_bf16_f32 v68, v192, v193
  v_cvt_pk_bf16_f32 v69, v194, v195
  v_cvt_pk_bf16_f32 v70, v196, v197
  v_cvt_pk_bf16_f32 v71, v198, v199
  s_add_u32 s72, s31, 4096
  buffer_store_dwordx4 v[64:67], v1, s[48:51], s72 offen offset:0 sc1
  buffer_store_dwordx4 v[68:71], v1, s[48:51], s72 offen offset:1024 sc1
  v_pk_mul_f32 v[184:185], v[80:81], v[80:81]
  v_pk_mul_f32 v[186:187], v[82:83], v[82:83]
  v_pk_mul_f32 v[188:189], v[84:85], v[84:85]
  v_pk_mul_f32 v[190:191], v[86:87], v[86:87]
  v_pk_mul_f32 v[192:193], v[88:89], v[88:89]
  v_pk_mul_f32 v[194:195], v[90:91], v[90:91]
  v_pk_mul_f32 v[196:197], v[92:93], v[92:93]
  v_pk_mul_f32 v[198:199], v[94:95], v[94:95]
  v_pk_fma_f32 v[184:185], v[184:185], s[12:13], v[18:19] op_sel:[0,1,1] op_sel_hi:[1,1,1]
  v_pk_fma_f32 v[186:187], v[186:187], s[12:13], v[18:19] op_sel:[0,1,1] op_sel_hi:[1,1,1]
  v_pk_fma_f32 v[188:189], v[188:189], s[12:13], v[18:19] op_sel:[0,1,1] op_sel_hi:[1,1,1]
  v_pk_fma_f32 v[190:191], v[190:191], s[12:13], v[18:19] op_sel:[0,1,1] op_sel_hi:[1,1,1]
  v_pk_fma_f32 v[192:193], v[192:193], s[12:13], v[18:19] op_sel:[0,1,1] op_sel_hi:[1,1,1]
  v_pk_fma_f32 v[194:195], v[194:195], s[12:13], v[18:19] op_sel:[0,1,1] op_sel_hi:[1,1,1]
  v_pk_fma_f32 v[196:197], v[196:197], s[12:13], v[18:19] op_sel:[0,1,1] op_sel_hi:[1,1,1]
  v_pk_fma_f32 v[198:199], v[198:199], s[12:13], v[18:19] op_sel:[0,1,1] op_sel_hi:[1,1,1]
  v_pk_mul_f32 v[184:185], v[184:185], v[80:81]
  v_pk_mul_f32 v[186:187], v[186:187], v[82:83]
  v_pk_mul_f32 v[188:189], v[188:189], v[84:85]
  v_pk_mul_f32 v[190:191], v[190:191], v[86:87]
  v_pk_mul_f32 v[192:193], v[192:193], v[88:89]
  v_pk_mul_f32 v[194:195], v[194:195], v[90:91]
  v_pk_mul_f32 v[196:197], v[196:197], v[92:93]
  v_pk_mul_f32 v[198:199], v[198:199], v[94:95]
  v_exp_f32 v184, v184
  v_exp_f32 v185, v185
  v_exp_f32 v186, v186
  v_exp_f32 v187, v187
  v_exp_f32 v188, v188
  v_exp_f32 v189, v189
  v_exp_f32 v190, v190
  v_exp_f32 v191, v191
  v_exp_f32 v192, v192
  v_exp_f32 v193, v193
  v_exp_f32 v194, v194
  v_exp_f32 v195, v195
  v_exp_f32 v196, v196
  v_exp_f32 v197, v197
  v_exp_f32 v198, v198
  v_exp_f32 v199, v199
  v_pk_add_f32 v[184:185], v[184:185], 1.0 op_sel_hi:[1,0]
  v_pk_add_f32 v[186:187], v[186:187], 1.0 op_sel_hi:[1,0]
  v_pk_add_f32 v[188:189], v[188:189], 1.0 op_sel_hi:[1,0]
  v_pk_add_f32 v[190:191], v[190:191], 1.0 op_sel_hi:[1,0]
  v_pk_add_f32 v[192:193], v[192:193], 1.0 op_sel_hi:[1,0]
  v_pk_add_f32 v[194:195], v[194:195], 1.0 op_sel_hi:[1,0]
  v_pk_add_f32 v[196:197], v[196:197], 1.0 op_sel_hi:[1,0]
  v_pk_add_f32 v[198:199], v[198:199], 1.0 op_sel_hi:[1,0]
  v_rcp_f32 v184, v184
  v_rcp_f32 v185, v185
  v_rcp_f32 v186, v186
  v_rcp_f32 v187, v187
  v_rcp_f32 v188, v188
  v_rcp_f32 v189, v189
  v_rcp_f32 v190, v190
  v_rcp_f32 v191, v191
  v_rcp_f32 v192, v192
  v_rcp_f32 v193, v193
  v_rcp_f32 v194, v194
  v_rcp_f32 v195, v195
  v_rcp_f32 v196, v196
  v_rcp_f32 v197, v197
  v_rcp_f32 v198, v198
  v_rcp_f32 v199, v199
  v_pk_mul_f32 v[184:185], v[184:185], v[80:81]
  v_pk_mul_f32 v[186:187], v[186:187], v[82:83]
  v_pk_mul_f32 v[188:189], v[188:189], v[84:85]
  v_pk_mul_f32 v[190:191], v[190:191], v[86:87]
  v_pk_mul_f32 v[192:193], v[192:193], v[88:89]
  v_pk_mul_f32 v[194:195], v[194:195], v[90:91]
  v_pk_mul_f32 v[196:197], v[196:197], v[92:93]
  v_pk_mul_f32 v[198:199], v[198:199], v[94:95]
  v_cvt_pk_bf16_f32 v80, v184, v185
  v_cvt_pk_bf16_f32 v81, v186, v187
  v_cvt_pk_bf16_f32 v82, v188, v189
  v_cvt_pk_bf16_f32 v83, v190, v191
  v_cvt_pk_bf16_f32 v84, v192, v193
  v_cvt_pk_bf16_f32 v85, v194, v195
  v_cvt_pk_bf16_f32 v86, v196, v197
  v_cvt_pk_bf16_f32 v87, v198, v199
  s_add_u32 s72, s31, 126976
  buffer_store_dwordx4 v[80:83], v1, s[48:51], s72 offen offset:0 sc1
  buffer_store_dwordx4 v[84:87], v1, s[48:51], s72 offen offset:1024 sc1
  s_cmp_lg_u32 s3, 0
  s_cbranch_scc1 L_mf2
  v_pk_mul_f32 v[184:185], v[96:97], v[96:97]
  v_pk_mul_f32 v[186:187], v[98:99], v[98:99]
  v_pk_mul_f32 v[188:189], v[100:101], v[100:101]
  v_pk_mul_f32 v[190:191], v[102:103], v[102:103]
  v_pk_mul_f32 v[192:193], v[104:105], v[104:105]
  v_pk_mul_f32 v[194:195], v[106:107], v[106:107]
  v_pk_mul_f32 v[196:197], v[108:109], v[108:109]
  v_pk_mul_f32 v[198:199], v[110:111], v[110:111]
  v_pk_fma_f32 v[184:185], v[184:185], s[12:13], v[18:19] op_sel:[0,1,1] op_sel_hi:[1,1,1]
  v_pk_fma_f32 v[186:187], v[186:187], s[12:13], v[18:19] op_sel:[0,1,1] op_sel_hi:[1,1,1]
  v_pk_fma_f32 v[188:189], v[188:189], s[12:13], v[18:19] op_sel:[0,1,1] op_sel_hi:[1,1,1]
  v_pk_fma_f32 v[190:191], v[190:191], s[12:13], v[18:19] op_sel:[0,1,1] op_sel_hi:[1,1,1]
  v_pk_fma_f32 v[192:193], v[192:193], s[12:13], v[18:19] op_sel:[0,1,1] op_sel_hi:[1,1,1]
  v_pk_fma_f32 v[194:195], v[194:195], s[12:13], v[18:19] op_sel:[0,1,1] op_sel_hi:[1,1,1]
  v_pk_fma_f32 v[196:197], v[196:197], s[12:13], v[18:19] op_sel:[0,1,1] op_sel_hi:[1,1,1]
  v_pk_fma_f32 v[198:199], v[198:199], s[12:13], v[18:19] op_sel:[0,1,1] op_sel_hi:[1,1,1]
  v_pk_mul_f32 v[184:185], v[184:185], v[96:97]
  v_pk_mul_f32 v[186:187], v[186:187], v[98:99]
  v_pk_mul_f32 v[188:189], v[188:189], v[100:101]
  v_pk_mul_f32 v[190:191], v[190:191], v[102:103]
  v_pk_mul_f32 v[192:193], v[192:193], v[104:105]
  v_pk_mul_f32 v[194:195], v[194:195], v[106:107]
  v_pk_mul_f32 v[196:197], v[196:197], v[108:109]
  v_pk_mul_f32 v[198:199], v[198:199], v[110:111]
  v_exp_f32 v184, v184
  v_exp_f32 v185, v185
  v_exp_f32 v186, v186
  v_exp_f32 v187, v187
  v_exp_f32 v188, v188
  v_exp_f32 v189, v189
  v_exp_f32 v190, v190
  v_exp_f32 v191, v191
  v_exp_f32 v192, v192
  v_exp_f32 v193, v193
  v_exp_f32 v194, v194
  v_exp_f32 v195, v195
  v_exp_f32 v196, v196
  v_exp_f32 v197, v197
  v_exp_f32 v198, v198
  v_exp_f32 v199, v199
  v_pk_add_f32 v[184:185], v[184:185], 1.0 op_sel_hi:[1,0]
  v_pk_add_f32 v[186:187], v[186:187], 1.0 op_sel_hi:[1,0]
  v_pk_add_f32 v[188:189], v[188:189], 1.0 op_sel_hi:[1,0]
  v_pk_add_f32 v[190:191], v[190:191], 1.0 op_sel_hi:[1,0]
  v_pk_add_f32 v[192:193], v[192:193], 1.0 op_sel_hi:[1,0]
  v_pk_add_f32 v[194:195], v[194:195], 1.0 op_sel_hi:[1,0]
  v_pk_add_f32 v[196:197], v[196:197], 1.0 op_sel_hi:[1,0]
  v_pk_add_f32 v[198:199], v[198:199], 1.0 op_sel_hi:[1,0]
  v_rcp_f32 v184, v184
  v_rcp_f32 v185, v185
  v_rcp_f32 v186, v186
  v_rcp_f32 v187, v187
  v_rcp_f32 v188, v188
  v_rcp_f32 v189, v189
  v_rcp_f32 v190, v190
  v_rcp_f32 v191, v191
  v_rcp_f32 v192, v192
  v_rcp_f32 v193, v193
  v_rcp_f32 v194, v194
  v_rcp_f32 v195, v195
  v_rcp_f32 v196, v196
  v_rcp_f32 v197, v197
  v_rcp_f32 v198, v198
  v_rcp_f32 v199, v199
  v_pk_mul_f32 v[184:185], v[184:185], v[96:97]
  v_pk_mul_f32 v[186:187], v[186:187], v[98:99]
  v_pk_mul_f32 v[188:189], v[188:189], v[100:101]
  v_pk_mul_f32 v[190:191], v[190:191], v[102:103]
  v_pk_mul_f32 v[192:193], v[192:193], v[104:105]
  v_pk_mul_f32 v[194:195], v[194:195], v[106:107]
  v_pk_mul_f32 v[196:197], v[196:197], v[108:109]
  v_pk_mul_f32 v[198:199], v[198:199], v[110:111]
  v_cvt_pk_bf16_f32 v96, v184, v185
  v_cvt_pk_bf16_f32 v97, v186, v187
  v_cvt_pk_bf16_f32 v98, v188, v189
  v_cvt_pk_bf16_f32 v99, v190, v191
  v_cvt_pk_bf16_f32 v100, v192, v193
  v_cvt_pk_bf16_f32 v101, v194, v195
  v_cvt_pk_bf16_f32 v102, v196, v197
  v_cvt_pk_bf16_f32 v103, v198, v199
  s_add_u32 s72, s31, 8192
  buffer_store_dwordx4 v[96:99], v1, s[48:51], s72 offen offset:0 sc1
  buffer_store_dwordx4 v[100:103], v1, s[48:51], s72 offen offset:1024 sc1
  v_pk_mul_f32 v[184:185], v[112:113], v[112:113]
  v_pk_mul_f32 v[186:187], v[114:115], v[114:115]
  v_pk_mul_f32 v[188:189], v[116:117], v[116:117]
  v_pk_mul_f32 v[190:191], v[118:119], v[118:119]
  v_pk_mul_f32 v[192:193], v[120:121], v[120:121]
  v_pk_mul_f32 v[194:195], v[122:123], v[122:123]
  v_pk_mul_f32 v[196:197], v[124:125], v[124:125]
  v_pk_mul_f32 v[198:199], v[126:127], v[126:127]
  v_pk_fma_f32 v[184:185], v[184:185], s[12:13], v[18:19] op_sel:[0,1,1] op_sel_hi:[1,1,1]
  v_pk_fma_f32 v[186:187], v[186:187], s[12:13], v[18:19] op_sel:[0,1,1] op_sel_hi:[1,1,1]
  v_pk_fma_f32 v[188:189], v[188:189], s[12:13], v[18:19] op_sel:[0,1,1] op_sel_hi:[1,1,1]
  v_pk_fma_f32 v[190:191], v[190:191], s[12:13], v[18:19] op_sel:[0,1,1] op_sel_hi:[1,1,1]
  v_pk_fma_f32 v[192:193], v[192:193], s[12:13], v[18:19] op_sel:[0,1,1] op_sel_hi:[1,1,1]
  v_pk_fma_f32 v[194:195], v[194:195], s[12:13], v[18:19] op_sel:[0,1,1] op_sel_hi:[1,1,1]
  v_pk_fma_f32 v[196:197], v[196:197], s[12:13], v[18:19] op_sel:[0,1,1] op_sel_hi:[1,1,1]
  v_pk_fma_f32 v[198:199], v[198:199], s[12:13], v[18:19] op_sel:[0,1,1] op_sel_hi:[1,1,1]
  v_pk_mul_f32 v[184:185], v[184:185], v[112:113]
  v_pk_mul_f32 v[186:187], v[186:187], v[114:115]
  v_pk_mul_f32 v[188:189], v[188:189], v[116:117]
  v_pk_mul_f32 v[190:191], v[190:191], v[118:119]
  v_pk_mul_f32 v[192:193], v[192:193], v[120:121]
  v_pk_mul_f32 v[194:195], v[194:195], v[122:123]
  v_pk_mul_f32 v[196:197], v[196:197], v[124:125]
  v_pk_mul_f32 v[198:199], v[198:199], v[126:127]
  v_exp_f32 v184, v184
  v_exp_f32 v185, v185
  v_exp_f32 v186, v186
  v_exp_f32 v187, v187
  v_exp_f32 v188, v188
  v_exp_f32 v189, v189
  v_exp_f32 v190, v190
  v_exp_f32 v191, v191
  v_exp_f32 v192, v192
  v_exp_f32 v193, v193
  v_exp_f32 v194, v194
  v_exp_f32 v195, v195
  v_exp_f32 v196, v196
  v_exp_f32 v197, v197
  v_exp_f32 v198, v198
  v_exp_f32 v199, v199
  v_pk_add_f32 v[184:185], v[184:185], 1.0 op_sel_hi:[1,0]
  v_pk_add_f32 v[186:187], v[186:187], 1.0 op_sel_hi:[1,0]
  v_pk_add_f32 v[188:189], v[188:189], 1.0 op_sel_hi:[1,0]
  v_pk_add_f32 v[190:191], v[190:191], 1.0 op_sel_hi:[1,0]
  v_pk_add_f32 v[192:193], v[192:193], 1.0 op_sel_hi:[1,0]
  v_pk_add_f32 v[194:195], v[194:195], 1.0 op_sel_hi:[1,0]
  v_pk_add_f32 v[196:197], v[196:197], 1.0 op_sel_hi:[1,0]
  v_pk_add_f32 v[198:199], v[198:199], 1.0 op_sel_hi:[1,0]
  v_rcp_f32 v184, v184
  v_rcp_f32 v185, v185
  v_rcp_f32 v186, v186
  v_rcp_f32 v187, v187
  v_rcp_f32 v188, v188
  v_rcp_f32 v189, v189
  v_rcp_f32 v190, v190
  v_rcp_f32 v191, v191
  v_rcp_f32 v192, v192
  v_rcp_f32 v193, v193
  v_rcp_f32 v194, v194
  v_rcp_f32 v195, v195
  v_rcp_f32 v196, v196
  v_rcp_f32 v197, v197
  v_rcp_f32 v198, v198
  v_rcp_f32 v199, v199
  v_pk_mul_f32 v[184:185], v[184:185], v[112:113]
  v_pk_mul_f32 v[186:187], v[186:187], v[114:115]
  v_pk_mul_f32 v[188:189], v[188:189], v[116:117]
  v_pk_mul_f32 v[190:191], v[190:191], v[118:119]
  v_pk_mul_f32 v[192:193], v[192:193], v[120:121]
  v_pk_mul_f32 v[194:195], v[194:195], v[122:123]
  v_pk_mul_f32 v[196:197], v[196:197], v[124:125]
  v_pk_mul_f32 v[198:199], v[198:199], v[126:127]
  v_cvt_pk_bf16_f32 v112, v184, v185
  v_cvt_pk_bf16_f32 v113, v186, v187
  v_cvt_pk_bf16_f32 v114, v188, v189
  v_cvt_pk_bf16_f32 v115, v190, v191
  v_cvt_pk_bf16_f32 v116, v192, v193
  v_cvt_pk_bf16_f32 v117, v194, v195
  v_cvt_pk_bf16_f32 v118, v196, v197
  v_cvt_pk_bf16_f32 v119, v198, v199
  s_add_u32 s72, s31, 131072
  buffer_store_dwordx4 v[112:115], v1, s[48:51], s72 offen offset:0 sc1
  buffer_store_dwordx4 v[116:119], v1, s[48:51], s72 offen offset:1024 sc1
L_mf2:
  s_barrier
L_mt:
  v_lshrrev_b32 v28, 3, v0
  v_and_b32 v29, 7, v0
  v_lshlrev_b32 v30, 4, v29
  v_lshl_add_u32 v2, v28, 10, v30
  s_and_b32 s72, s63, 1
  s_lshl_b32 s72, s72, 3
  v_add_u32 v30, s72, v28
  v_lshlrev_b32 v29, 1, v29
  v_xor_b32 v29, v29, v30
  v_lshlrev_b32 v29, 4, v29
  v_lshl_add_u32 v28, v28, 8, v29
  s_lshl_b32 s72, s63, 13
  s_add_u32 s74, s72, 40960
  v_add_u32 v3, s74, v28
  v_xor_b32 v4, 16, v3
  s_lshl_b32 s31, s64, 16
  s_add_u32 s31, s31, s30
  s_add_u32 s31, s31, s72
  s_mov_b32 s73, s12
  s_waitcnt vmcnt(0)
  v_mov_b32 v28, s68
  v_mov_b32 v29, s69
  v_lshrrev_b32_e64 v30, 1, v1
  s_mov_b64 exec, 0xffff
  buffer_store_dwordx2 v[28:29], v30, s[48:51], s73 offen sc1
  s_mov_b64 exec, -1
  s_barrier
  ds_read_b128 v[32:35], v3 offset:0
  ds_read_b128 v[36:39], v4 offset:0
  ds_read_b128 v[40:43], v3 offset:2048
  ds_read_b128 v[44:47], v4 offset:2048
  ds_read_b128 v[48:51], v3 offset:4096
  ds_read_b128 v[52:55], v4 offset:4096
  ds_read_b128 v[56:59], v3 offset:6144
  ds_read_b128 v[60:63], v4 offset:6144
  s_waitcnt lgkmcnt(4)
  v_pk_add_f32 v[32:33], v[32:33], v[40:41]
  v_pk_add_f32 v[34:35], v[34:35], v[42:43]
  v_pk_add_f32 v[36:37], v[36:37], v[44:45]
  v_pk_add_f32 v[38:39], v[38:39], v[46:47]
  s_waitcnt lgkmcnt(2)
  v_pk_add_f32 v[32:33], v[32:33], v[48:49]
  v_pk_add_f32 v[34:35], v[34:35], v[50:51]
  v_pk_add_f32 v[36:37], v[36:37], v[52:53]
  v_pk_add_f32 v[38:39], v[38:39], v[54:55]
  s_waitcnt lgkmcnt(0)
  v_pk_add_f32 v[32:33], v[32:33], v[56:57]
  v_pk_add_f32 v[34:35], v[34:35], v[58:59]
  v_pk_add_f32 v[36:37], v[36:37], v[60:61]
  v_pk_add_f32 v[38:39], v[38:39], v[62:63]
  v_cvt_pk_bf16_f32 v40, v32, v33
  v_cvt_pk_bf16_f32 v41, v34, v35
  v_cvt_pk_bf16_f32 v42, v36, v37
  v_cvt_pk_bf16_f32 v43, v38, v39
  buffer_store_dwordx4 v[40:43], v2, s[52:55], s31 offen
  s_add_u32 s31, s31, 32768
  s_barrier
  ds_read_b128 v[64:67], v3 offset:32768
  ds_read_b128 v[68:71], v4 offset:32768
  ds_read_b128 v[72:75], v3 offset:34816
  ds_read_b128 v[76:79], v4 offset:34816
  ds_read_b128 v[80:83], v3 offset:36864
  ds_read_b128 v[84:87], v4 offset:36864
  ds_read_b128 v[88:91], v3 offset:38912
  ds_read_b128 v[92:95], v4 offset:38912
  s_waitcnt lgkmcnt(4)
  v_pk_add_f32 v[64:65], v[64:65], v[72:73]
  v_pk_add_f32 v[66:67], v[66:67], v[74:75]
  v_pk_add_f32 v[68:69], v[68:69], v[76:77]
  v_pk_add_f32 v[70:71], v[70:71], v[78:79]
  s_waitcnt lgkmcnt(2)
  v_pk_add_f32 v[64:65], v[64:65], v[80:81]
  v_pk_add_f32 v[66:67], v[66:67], v[82:83]
  v_pk_add_f32 v[68:69], v[68:69], v[84:85]
  v_pk_add_f32 v[70:71], v[70:71], v[86:87]
  s_waitcnt lgkmcnt(0)
  v_pk_add_f32 v[64:65], v[64:65], v[88:89]
  v_pk_add_f32 v[66:67], v[66:67], v[90:91]
  v_pk_add_f32 v[68:69], v[68:69], v[92:93]
  v_pk_add_f32 v[70:71], v[70:71], v[94:95]
  v_cvt_pk_bf16_f32 v72, v64, v65
  v_cvt_pk_bf16_f32 v73, v66, v67
  v_cvt_pk_bf16_f32 v74, v68, v69
  v_cvt_pk_bf16_f32 v75, v70, v71
  buffer_store_dwordx4 v[72:75], v2, s[52:55], s31 offen
L_end:
  s_endpgm
.fill 8192, 4, 0xbf800000
.section .rodata,"a"
.p2align 6
.amdhsa_kernel gated_mix__linear_kernel_hedgehog__dense_activation_gelu__prompt_kernel
  .amdhsa_next_free_vgpr 256
  .amdhsa_next_free_sgpr 102
  .amdhsa_accum_offset 256
  .amdhsa_group_segment_fixed_size 0
  .amdhsa_kernarg_size 104
  .amdhsa_user_sgpr_count 2
  .amdhsa_user_sgpr_kernarg_segment_ptr 1
  .amdhsa_system_sgpr_workgroup_id_x 1
.end_amdhsa_kernel
```
